```python
import torch

def _softmax(x, axis=-1):
    return torch.softmax(x, dim=axis)
def _gelu(x):
    return torch.nn.functional.gelu(x, approximate="tanh")
def _silu(x):
    return torch.nn.functional.silu(x)
def _sigmoid(x):
    return torch.sigmoid(x)
def _layernorm(x, axis=-1, eps=1e-5):
    m = x.mean(dim=axis, keepdim=True)
    v = x.var(dim=axis, keepdim=True, unbiased=False)
    return (x - m) / torch.sqrt(v + eps)
def _scatter_add(tgt, idx, src, axis=0):
    return tgt.clone().index_add_(axis, idx, src)
def _segment_sum(src, seg, n):
    out = torch.zeros((n,) + src.shape[1:], dtype=src.dtype)
    return out.index_add_(0, seg, src)
def _pad(x, pw):
    flat = tuple(v for pair in reversed(pw) for v in pair)
    return torch.nn.functional.pad(x, flat)

kernel_name = 'sequential_preLN__sliding_local_dilated__glu_gated_geglu__prompt'

def setup_inputs():

    _w = (lambda a: (lambda t: t.to(torch.bfloat16) if t.is_floating_point() else t)(torch.as_tensor(a)))
    def _A_setup():
        B, S, D = 1, 2048, 512
        return {
            "x": _w((lambda *s: torch.randn(*s, dtype=torch.bfloat16) * 0.05)(B, S, D)),
            "wqkv": _w((lambda *s: torch.randn(*s, dtype=torch.bfloat16) * 0.05)(D, 3 * D)),
            "wo": _w((lambda *s: torch.randn(*s, dtype=torch.bfloat16) * 0.05)(D, D)),
        }
    _A_in = _A_setup()

    def _B_setup():
        B, S, Dm, Df = 1, 2048, 512, 1376
        return {
            "x": _w((lambda *s: torch.randn(*s, dtype=torch.bfloat16) * 0.05)(B, S, Dm)),
            "w_gate": _w((lambda *s: torch.randn(*s, dtype=torch.bfloat16) * 0.8)(Dm, Df) * (Dm ** -0.5)),
            "w_up": _w((lambda *s: torch.randn(*s, dtype=torch.bfloat16) * 0.8)(Dm, Df) * (Dm ** -0.5)),
            "w_down": _w((lambda *s: torch.randn(*s, dtype=torch.bfloat16) * 0.8)(Df, Dm) * (Df ** -0.5)),
        }
    _B_in = _B_setup()

    return {
        "A_x": _A_in["x"],
        "A_wqkv": _A_in["wqkv"],
        "A_wo": _A_in["wo"],
        "B_x": _B_in["x"],
        "B_w_gate": _B_in["w_gate"],
        "B_w_up": _B_in["w_up"],
        "B_w_down": _B_in["w_down"],
    }

def reference(A_x, A_wqkv, A_wo, B_x, B_w_gate, B_w_up, B_w_down):
    def _A_ref(x, wqkv, wo):
        B, S, D = x.shape
        H = 32; Dh = D // H
        W, dil = 8, 2
        qkv = (lambda x, *d: x.permute(*d))((x @ wqkv).reshape(B, S, 3, H, Dh), 2, 0, 3, 1, 4)
        q, k, v = qkv[0], qkv[1], qkv[2]
        scale = Dh ** -0.5
        pos = torch.arange(S)
        off = torch.arange(W) * dil
        idx = pos[:, None] - off[None, :]
        mask = idx >= 0
        idx_c = torch.where(mask, idx, 0).reshape(-1)
        kg = k[:, :, idx_c, :].reshape(B, H, S, W, Dh)
        vg = v[:, :, idx_c, :].reshape(B, H, S, W, Dh)
        logits = torch.einsum("bhsd,bhswd->bhsw", q, kg) * scale
        logits = torch.where(mask[None, None, :, :], logits, -1e9)
        attn = _softmax(logits, axis=-1)
        o = torch.einsum("bhsw,bhswd->bhsd", attn, vg)
        return (lambda x, *d: x.permute(*d))(o, 0, 2, 1, 3).reshape(B, S, D) @ wo

    def _B_ref(x, w_gate, w_up, w_down):
        g = torch.einsum("bsd,df->bsf", x, w_gate)
        u = torch.einsum("bsd,df->bsf", x, w_up)
        h = _gelu(g) * u
        return torch.einsum("bsf,fd->bsd", h, w_down)

    x = A_x
    h = x + _A_ref(_layernorm(x, axis=-1), A_wqkv, A_wo)
    h2 = h + _B_ref(_layernorm(h, axis=-1), B_w_gate, B_w_up, B_w_down)
    return h2
```

```asm
; @launch grid=(256,1,1) block=(512,1,1) lds=163840
.amdgcn_target "amdgcn-amd-amdhsa--gfx950"
.text
.globl sequential_preLN__sliding_local_dilated__glu_gated_geglu__prompt_kernel
.p2align 8
.type sequential_preLN__sliding_local_dilated__glu_gated_geglu__prompt_kernel,@function
sequential_preLN__sliding_local_dilated__glu_gated_geglu__prompt_kernel:
    s_cmp_ge_u32 s2, 256
    s_cbranch_scc1 L_end
    s_load_dwordx16 s[16:31], s[0:1], 0
    s_load_dwordx4 s[32:35], s[0:1], 64
    s_getpc_b64 s[8:9]
L_pc:
    v_lshrrev_b32 v1, 6, v0
    v_and_b32 v0, 63, v0
    v_readfirstlane_b32 s15, v1
    s_and_b32 s13, s2, 7
    s_lshr_b32 s14, s2, 3
    s_mov_b32 s10, L_code_end-L_pc
    s_mov_b32 s11, 0x20000
    s_lshl_b32 s6, s15, 5
    s_add_u32 s6, s6, s14
    s_lshl_b32 s6, s6, 10
    v_lshlrev_b32 v1, 4, v0
    s_cmp_ge_u32 s6, s10
    s_cbranch_scc1 L_nopf
    buffer_load_dwordx4 a[76:79], v1, s[8:11], s6 offen
L_nopf:
    v_and_b32 v1, 15, v0
    v_lshrrev_b32 v2, 4, v0
    s_and_b32 s3, s15, 3
    s_and_b32 s39, s3, 1
    s_lshr_b32 s40, s3, 1
    s_lshr_b32 s4, s13, 1
    s_lshl_b32 s4, s4, 3
    s_lshr_b32 s5, s14, 2
    s_add_u32 s43, s4, s5
    s_and_b32 s4, s13, 1
    s_lshl_b32 s4, s4, 2
    s_and_b32 s5, s14, 3
    s_add_u32 s12, s4, s5
    s_cmp_lt_u32 s15, 4
    s_cbranch_scc1 L_compute
    s_setprio 2
    s_lshl_b32 s48, s43, 6
    s_and_b32 s4, s13, 1
    s_lshl_b32 s4, s4, 2
    s_and_b32 s5, s13, 6
    s_add_u32 s49, s4, s5
    s_and_b32 s4, s14, 1
    s_lshl_b32 s4, s4, 1
    s_add_u32 s49, s49, s4
    s_mul_i32 s4, s3, 16
    s_add_u32 s4, s4, s48
    v_lshrrev_b32 v8, 3, v0
    v_add_u32 v8, s4, v8
    v_mul_u32_u24 v8, 1024, v8
    v_and_b32 v9, 7, v0
    v_xor_b32 v9, v9, v2
    v_lshl_add_u32 v10, v9, 4, v8
    v_xor_b32 v9, 4, v9
    v_lshl_add_u32 v11, v9, 4, v8
    v_add_u32 v11, 7168, v11
    v_lshrrev_b32 v13, 3, v0
    v_and_b32 v14, 2, v13
    v_and_b32 v15, 7, v0
    v_xor_b32 v14, v14, v15
    s_lshl_b32 s4, s3, 4
    v_add_u32 v13, s4, v13
    v_mul_u32_u24 v13, 3072, v13
    s_lshl_b32 s4, s12, 7
    v_add_u32 v13, s4, v13
    v_lshl_add_u32 v16, v14, 4, v13
    v_xor_b32 v14, 4, v14
    v_lshl_add_u32 v17, v14, 4, v13
    v_add_u32 v17, 24576, v17
    s_lshl_b32 s4, s3, 3
    s_add_u32 s4, s4, s48
    s_sub_u32 s4, s4, 16
    v_lshrrev_b32 v13, 3, v0
    v_add_u32 v13, s4, v13
    v_max_i32 v13, 0, v13
    v_and_b32 v14, 7, v0
    v_xor_b32 v14, v14, v2
    s_lshl_b32 s4, s39, 2
    v_xor_b32 v14, s4, v14
    v_lshlrev_b32 v14, 4, v14
    v_lshl_add_u32 v12, v13, 10, v14
    s_mul_i32 s50, s3, 6144
    s_mul_i32 s51, s3, 3072
    s_lshl_b32 s52, s3, 10
    s_lshl_b32 s53, s3, 11
    s_waitcnt lgkmcnt(0)
    s_cmp_eq_u32 s3, 0
    s_cselect_b32 s23, 0xffffff00, -1
    s_waitcnt lgkmcnt(0)
    s_mov_b32 s56, s16
    s_mov_b32 s57, s17
    s_mov_b32 s58, 0x200000
    s_mov_b32 s59, 0x20000
    s_mov_b32 s60, s18
    s_mov_b32 s61, s19
    s_mov_b32 s62, 0x180000
    s_mov_b32 s63, 0x20000
    s_add_u32 s54, s49, 0
    s_and_b32 s54, s54, 7
    s_mul_i32 s55, s54, 196608
    s_lshl_b32 s54, s54, 7
    s_add_u32 m0, s53, 2048
    s_nop 0
    buffer_load_dwordx4 v10, s[56:59], s54 offen  lds
    buffer_load_dwordx4 v11, s[56:59], s54 offen offset:1024  lds
    s_add_u32 m0, s50, 10240
    s_nop 0
    buffer_load_dwordx4 v16, s[60:63], s55 offen  lds
    buffer_load_dwordx4 v16, s[60:63], s55 offen offset:1024  lds
    buffer_load_dwordx4 v16, s[60:63], s55 offen offset:2048  lds
    s_add_u32 m0, s50, 13312
    s_nop 0
    buffer_load_dwordx4 v17, s[60:63], s55 offen  lds
    buffer_load_dwordx4 v17, s[60:63], s55 offen offset:1024  lds
    buffer_load_dwordx4 v17, s[60:63], s55 offen offset:2048  lds
    s_cmp_ge_u32 s3, 2
    s_cbranch_scc1 L_1
    s_add_u32 m0, s52, 0
    s_mov_b32 exec_lo, s23
    s_nop 0
    buffer_load_dwordx4 v12, s[56:59], s54 offen lds
    s_mov_b32 exec_lo, -1
L_1:
    s_add_u32 s54, s49, 1
    s_and_b32 s54, s54, 7
    s_mul_i32 s55, s54, 196608
    s_lshl_b32 s54, s54, 7
    s_add_u32 m0, s53, 36864
    s_nop 0
    buffer_load_dwordx4 v10, s[56:59], s54 offen  lds
    buffer_load_dwordx4 v11, s[56:59], s54 offen offset:1024  lds
    s_add_u32 m0, s50, 45056
    s_nop 0
    buffer_load_dwordx4 v16, s[60:63], s55 offen  lds
    buffer_load_dwordx4 v16, s[60:63], s55 offen offset:1024  lds
    buffer_load_dwordx4 v16, s[60:63], s55 offen offset:2048  lds
    s_branch L_h2
L_compute:
    v_lshrrev_b32 v154, 3, v0
    v_lshlrev_b32 v154, 10, v154
    v_and_b32 v155, 7, v0
    v_lshl_add_u32 v154, v155, 4, v154
    s_lshl_b32 s4, s14, 2
    s_add_u32 s4, s4, s3
    s_mul_i32 s5, s4, 12288
    s_bitcmp1_b32 s13, 0
    s_cselect_b32 s5, 0x1000000, s5
    s_setprio 3
    s_waitcnt lgkmcnt(0)
    s_mov_b32 s48, s18
    s_mov_b32 s49, s19
    s_mov_b32 s50, 0x180000
    s_mov_b32 s51, 0x20000
    buffer_load_dwordx4 v[128:131], v154, s[48:51], s5 offen offset:384
    s_add_u32 s5, s5, 4096
    buffer_load_dwordx4 v[128:131], v154, s[48:51], s5 offen offset:384
    s_mov_b32 s52, s20
    s_mov_b32 s53, s21
    s_mov_b32 s54, 0x80000
    s_mov_b32 s55, 0x20000
    s_lshl_b32 s4, s4, 13
    buffer_load_dwordx4 v[128:131], v154, s[52:55], s4 offen offset:384
    s_setprio 0
    v_lshrrev_b32 v154, 1, v1
    v_xor_b32 v154, v154, v2
    v_lshlrev_b32 v154, 4, v154
    v_lshl_add_u32 v154, v1, 7, v154
    s_lshl_b32 s4, s39, 6
    v_xor_b32 v154, s4, v154
    v_add_u32 v132, 0, v154
    v_xor_b32 v135, 64, v132
    v_add_u32 v133, 34816, v154
    v_xor_b32 v136, 64, v133
    v_add_u32 v134, 69632, v154
    v_xor_b32 v137, 64, v134
    v_and_b32 v156, 1, v2
    v_lshrrev_b32 v154, 3, v1
    v_lshl_or_b32 v154, v156, 1, v154
    v_xor_b32 v154, s3, v154
    v_lshlrev_b32 v154, 5, v154
    v_lshrrev_b32 v155, 2, v1
    v_lshl_add_u32 v154, v155, 7, v154
    v_and_b32 v155, 3, v1
    v_lshl_add_u32 v154, v155, 3, v154
    v_mul_u32_u24 v155, 3072, v2
    v_add_u32 v154, v154, v155
    s_mul_i32 s4, s39, 12288
    s_sub_u32 s5, 12288, s4
    s_add_u32 s6, s4, 10240
    v_add_u32 v138, s6, v154
    s_add_u32 s6, s5, 10240
    v_add_u32 v141, s6, v154
    s_add_u32 s6, s4, 45056
    v_add_u32 v139, s6, v154
    s_add_u32 s6, s5, 45056
    v_add_u32 v142, s6, v154
    s_add_u32 s6, s4, 79872
    v_add_u32 v140, s6, v154
    s_add_u32 s6, s5, 79872
    v_add_u32 v143, s6, v154
    v_mov_b32 v154, 0x3f803f80
    v_accvgpr_write_b32 a64, v154
    v_accvgpr_write_b32 a65, v154
    v_accvgpr_write_b32 a66, v154
    v_accvgpr_write_b32 a67, v154
    v_lshlrev_b32 v155, 2, v0
    v_and_b32 v155, 127, v155
    s_min_u32 s4, s3, 2
    s_mul_i32 s4, s4, 34816
    v_add_u32 v155, s4, v155
    ds_write_b32 v155, v154 offset:0
    s_waitcnt lgkmcnt(0)
    s_lshr_b32 s6, s14, 4
    s_lshl_b32 s36, s13, 1
    s_add_u32 s36, s36, s6
    s_and_b32 s37, s14, 7
    s_lshr_b32 s6, s14, 3
    s_lshl_b32 s4, s13, 2
    s_add_u32 s6, s6, s4
    s_lshl_b32 s38, s6, 6
    s_lshr_b32 s4, s13, 2
    s_lshl_b32 s4, s4, 3
    s_lshr_b32 s5, s14, 2
    s_add_u32 s41, s4, s5
    s_and_b32 s4, s13, 3
    s_lshl_b32 s4, s4, 2
    s_and_b32 s5, s14, 3
    s_add_u32 s42, s4, s5
    v_mov_b32 v4, 0
    v_mov_b32 v5, 1
    s_add_u32 s44, s34, 0xa00000
    s_addc_u32 s45, s35, 0
    s_mov_b32 s46, 0x100000
    s_mov_b32 s47, 0x20000
    s_mov_b32 s48, s32
    s_mov_b32 s49, s33
    s_mov_b32 s50, 0x100
    s_mov_b32 s51, 0x20000
    s_and_b32 s4, s14, 15
    s_lshl_b32 s4, s4, 2
    s_add_u32 s52, s4, s3
    v_lshlrev_b32 v154, 7, v0
    s_lshl_b32 s5, s36, 13
    s_add_u32 s5, s5, 0x80000
    s_cmp_lg_u32 s52, 3
    s_cbranch_scc1 L_28
    buffer_store_dword v4, v154, s[44:47], s5 offen sc1
L_28:
    s_lshl_b32 s53, s43, 6
    v_mov_b32 v157, 0xf149f2ca
    v_lshl_add_u32 v154, v2, 2, 0
    v_sub_u32 v154, v1, v154
    v_and_b32 v155, 0x80000001, v154
    v_cmp_eq_u32 vcc, 0, v155
    s_nop 1
    v_cndmask_b32_e64 v116, v157, 0, vcc
    v_cmp_eq_u32 vcc, 0x80000000, v155
    s_nop 1
    v_cndmask_b32_e64 v120, v157, 0, vcc
    v_lshl_add_u32 v154, v2, 2, 1
    v_sub_u32 v154, v1, v154
    v_and_b32 v155, 0x80000001, v154
    v_cmp_eq_u32 vcc, 0, v155
    s_nop 1
    v_cndmask_b32_e64 v117, v157, 0, vcc
    v_cmp_eq_u32 vcc, 0x80000000, v155
    s_nop 1
    v_cndmask_b32_e64 v121, v157, 0, vcc
    v_lshl_add_u32 v154, v2, 2, 2
    v_sub_u32 v154, v1, v154
    v_and_b32 v155, 0x80000001, v154
    v_cmp_eq_u32 vcc, 0, v155
    s_nop 1
    v_cndmask_b32_e64 v118, v157, 0, vcc
    v_cmp_eq_u32 vcc, 0x80000000, v155
    s_nop 1
    v_cndmask_b32_e64 v122, v157, 0, vcc
    v_lshl_add_u32 v154, v2, 2, 3
    v_sub_u32 v154, v1, v154
    v_and_b32 v155, 0x80000001, v154
    v_cmp_eq_u32 vcc, 0, v155
    s_nop 1
    v_cndmask_b32_e64 v119, v157, 0, vcc
    v_cmp_eq_u32 vcc, 0x80000000, v155
    s_nop 1
    v_cndmask_b32_e64 v123, v157, 0, vcc
    v_cmp_eq_u32 vcc, 0, v120
    v_mov_b32 v155, 0xffff
    s_nop 0
    v_cndmask_b32 v154, 0, v155, vcc
    v_cmp_eq_u32 vcc, 0, v121
    v_mov_b32 v155, 0xffff0000
    s_nop 0
    v_cndmask_b32 v154, v154, v155, vcc
    v_accvgpr_write_b32 a68, v154
    v_cmp_eq_u32 vcc, 0, v122
    v_mov_b32 v155, 0xffff
    s_nop 0
    v_cndmask_b32 v154, 0, v155, vcc
    v_cmp_eq_u32 vcc, 0, v123
    v_mov_b32 v155, 0xffff0000
    s_nop 0
    v_cndmask_b32 v154, v154, v155, vcc
    v_accvgpr_write_b32 a69, v154
    v_cmp_eq_u32 vcc, 0, v116
    v_mov_b32 v155, 0xffff
    s_nop 0
    v_cndmask_b32 v154, 0, v155, vcc
    v_cmp_eq_u32 vcc, 0, v117
    v_mov_b32 v155, 0xffff0000
    s_nop 0
    v_cndmask_b32 v154, v154, v155, vcc
    v_accvgpr_write_b32 a70, v154
    v_cmp_eq_u32 vcc, 0, v118
    v_mov_b32 v155, 0xffff
    s_nop 0
    v_cndmask_b32 v154, 0, v155, vcc
    v_cmp_eq_u32 vcc, 0, v119
    v_mov_b32 v155, 0xffff0000
    s_nop 0
    v_cndmask_b32 v154, v154, v155, vcc
    v_accvgpr_write_b32 a71, v154
    s_cmp_eq_u32 s53, 0
    s_cselect_b64 vcc, -1, 0
    v_cndmask_b32 v124, v120, v157, vcc
    v_cndmask_b32 v125, v121, v157, vcc
    v_cndmask_b32 v126, v122, v157, vcc
    v_cndmask_b32 v127, v123, v157, vcc
    s_mov_b32 s56, s34
    s_mov_b32 s57, s35
    s_mov_b32 s58, 0x200000
    s_mov_b32 s59, 0x20000
    v_lshlrev_b32 v164, 4, v0
    s_lshl_b32 s60, s53, 10
    s_lshl_b32 s4, s12, 12
    s_add_u32 s60, s60, s4
    s_lshl_b32 s4, s3, 10
    s_add_u32 s60, s60, s4
    s_cmp_lg_u32 s3, 0
    s_cbranch_scc1 L_29
    v_mov_b32 v154, 163584
    ds_write_b32 v154, v4
    ds_write_b32 v154, v4 offset:4
    ds_write_b32 v154, v4 offset:8
    ds_write_b32 v154, v4 offset:12
L_29:
    s_mov_b32 s4, 81920
    v_lshl_add_u32 v166, v0, 4, s4
    v_lshl_add_u32 v167, v1, 4, s4
    s_add_u32 s5, s4, 1280
    v_lshl_add_u32 v168, v0, 2, s5
    v_lshl_add_u32 v169, v1, 2, s5
    v_lshl_add_u32 v170, v2, 4, s5
    s_lshl_b32 s4, s3, 2
    v_add_u32 v165, s4, v167
    v_lshrrev_b32 v154, 2, v1
    v_cmp_eq_u32 vcc, v154, v2
    v_add_u32 v155, 768, v168
    s_nop 0
    v_cndmask_b32 v165, v155, v165, vcc
    s_mov_b32 s64, 0x200002
    s_mov_b32 s65, 0x20000200
    s_mov_b32 s66, 0x400004
    s_mov_b32 s67, 0x40000400
    s_mov_b32 s68, 0x800008
    s_mov_b32 s69, 0x80000800
    s_mov_b32 s70, 0x3b000000
    s_barrier
    ds_read_b64_tr_b16 a[24:25], v138 offset:1024
    ds_read_b64_tr_b16 a[26:27], v138 offset:1536
    ds_read_b128 a[0:3], v132 offset:0
    ds_read_b64_tr_b16 a[28:29], v138 offset:2048
    ds_read_b128 a[4:7], v132 offset:2048
    ds_read_b64_tr_b16 a[30:31], v138 offset:2560
    ds_read_b128 a[8:11], v132 offset:4096
    ds_read_b64_tr_b16 a[20:21], v138 offset:0
    ds_read_b64_tr_b16 a[22:23], v138 offset:512
    ds_read_b128 a[12:15], v132 offset:6144
    ds_read_b128 a[16:19], v132 offset:8192
    s_waitcnt lgkmcnt(0)
    v_mfma_f32_16x16x32_bf16 v[24:27], a[24:27], a[0:3], 0
    ds_read_b64_tr_b16 a[56:57], v141 offset:1024
    v_mfma_f32_16x16x32_bf16 v[44:47], a[0:3], a[28:31], 0
    ds_read_b64_tr_b16 a[58:59], v141 offset:1536
    v_mfma_f32_16x16x32_bf16 v[28:31], a[24:27], a[4:7], 0
    ds_read_b128 a[32:35], v135 offset:0
    v_mfma_f32_16x16x32_bf16 v[48:51], a[4:7], a[28:31], 0
    ds_read_b64_tr_b16 a[60:61], v141 offset:2048
    v_mfma_f32_16x16x32_bf16 v[8:11], a[20:23], a[4:7], 0
    ds_read_b128 a[36:39], v135 offset:2048
    v_mfma_f32_16x16x32_bf16 v[32:35], a[24:27], a[8:11], 0
    ds_read_b64_tr_b16 a[62:63], v141 offset:2560
    v_mfma_f32_16x16x32_bf16 v[52:55], a[8:11], a[28:31], 0
    ds_read_b128 a[40:43], v135 offset:4096
    v_mfma_f32_16x16x32_bf16 v[12:15], a[20:23], a[8:11], 0
    ds_read_b64_tr_b16 a[52:53], v141 offset:0
    v_mfma_f32_16x16x32_bf16 v[36:39], a[24:27], a[12:15], 0
    ds_read_b64_tr_b16 a[54:55], v141 offset:512
    v_mfma_f32_16x16x32_bf16 v[56:59], a[12:15], a[28:31], 0
    ds_read_b128 a[44:47], v135 offset:6144
    v_mfma_f32_16x16x32_bf16 v[16:19], a[20:23], a[12:15], 0
    ds_read_b128 a[48:51], v135 offset:8192
    v_mfma_f32_16x16x32_bf16 v[40:43], a[24:27], a[16:19], 0
    v_mfma_f32_16x16x32_bf16 v[60:63], a[16:19], a[28:31], 0
    v_mfma_f32_16x16x32_bf16 v[20:23], a[20:23], a[16:19], 0
    v_mfma_f32_16x16x32_bf16 v[104:107], a[20:23], a[64:67], 0
    s_cmp_lg_u32 s40, 0
    s_cbranch_scc1 L_30
    v_mfma_f32_16x16x32_bf16 v[64:67], a[0:3], a[0:3], 0
    v_mfma_f32_16x16x32_bf16 v[68:71], a[4:7], a[4:7], 0
    v_mfma_f32_16x16x32_bf16 v[72:75], a[8:11], a[8:11], 0
    v_mfma_f32_16x16x32_bf16 v[76:79], a[12:15], a[12:15], 0
    v_mfma_f32_16x16x32_bf16 v[80:83], a[16:19], a[16:19], 0
    s_branch L_31
L_30:
    s_nop 0
    v_mfma_f32_16x16x32_bf16 v[64:67], a[64:67], a[0:3], 0
    s_nop 1
    v_mfma_f32_16x16x32_bf16 v[68:71], a[64:67], a[4:7], 0
    s_nop 2
    v_mfma_f32_16x16x32_bf16 v[72:75], a[64:67], a[8:11], 0
    s_nop 3
    v_mfma_f32_16x16x32_bf16 v[76:79], a[64:67], a[12:15], 0
    s_nop 4
    v_mfma_f32_16x16x32_bf16 v[80:83], a[64:67], a[16:19], 0
L_31:
    s_waitcnt lgkmcnt(0)
    s_barrier
    v_mfma_f32_16x16x32_bf16 v[24:27], a[56:59], a[32:35], v[24:27]
    ds_read_b64_tr_b16 a[24:25], v139 offset:1024
    v_mfma_f32_16x16x32_bf16 v[44:47], a[32:35], a[60:63], v[44:47]
    ds_read_b64_tr_b16 a[26:27], v139 offset:1536
    v_mfma_f32_16x16x32_bf16 v[28:31], a[56:59], a[36:39], v[28:31]
    ds_read_b128 a[0:3], v133 offset:0
    v_mfma_f32_16x16x32_bf16 v[48:51], a[36:39], a[60:63], v[48:51]
    ds_read_b64_tr_b16 a[28:29], v139 offset:2048
    v_mfma_f32_16x16x32_bf16 v[8:11], a[52:55], a[36:39], v[8:11]
    ds_read_b128 a[4:7], v133 offset:2048
    v_mfma_f32_16x16x32_bf16 v[32:35], a[56:59], a[40:43], v[32:35]
    ds_read_b64_tr_b16 a[30:31], v139 offset:2560
    v_mfma_f32_16x16x32_bf16 v[52:55], a[40:43], a[60:63], v[52:55]
    ds_read_b128 a[8:11], v133 offset:4096
    v_mfma_f32_16x16x32_bf16 v[12:15], a[52:55], a[40:43], v[12:15]
    ds_read_b64_tr_b16 a[20:21], v139 offset:0
    v_mfma_f32_16x16x32_bf16 v[36:39], a[56:59], a[44:47], v[36:39]
    ds_read_b64_tr_b16 a[22:23], v139 offset:512
    v_mfma_f32_16x16x32_bf16 v[56:59], a[44:47], a[60:63], v[56:59]
    ds_read_b128 a[12:15], v133 offset:6144
    v_mfma_f32_16x16x32_bf16 v[16:19], a[52:55], a[44:47], v[16:19]
    ds_read_b128 a[16:19], v133 offset:8192
    v_mfma_f32_16x16x32_bf16 v[40:43], a[56:59], a[48:51], v[40:43]
    v_mfma_f32_16x16x32_bf16 v[60:63], a[48:51], a[60:63], v[60:63]
    v_mfma_f32_16x16x32_bf16 v[20:23], a[52:55], a[48:51], v[20:23]
    v_mfma_f32_16x16x32_bf16 v[104:107], a[52:55], a[64:67], v[104:107]
    s_waitcnt lgkmcnt(0)
    v_mfma_f32_16x16x32_bf16 v[24:27], a[24:27], a[0:3], v[24:27]
    ds_read_b64_tr_b16 a[56:57], v142 offset:1024
    v_mfma_f32_16x16x32_bf16 v[44:47], a[0:3], a[28:31], v[44:47]
    ds_read_b64_tr_b16 a[58:59], v142 offset:1536
    v_mfma_f32_16x16x32_bf16 v[28:31], a[24:27], a[4:7], v[28:31]
    ds_read_b128 a[32:35], v136 offset:0
    v_mfma_f32_16x16x32_bf16 v[48:51], a[4:7], a[28:31], v[48:51]
    ds_read_b64_tr_b16 a[60:61], v142 offset:2048
    v_mfma_f32_16x16x32_bf16 v[8:11], a[20:23], a[4:7], v[8:11]
    ds_read_b128 a[36:39], v136 offset:2048
    v_mfma_f32_16x16x32_bf16 v[32:35], a[24:27], a[8:11], v[32:35]
    ds_read_b64_tr_b16 a[62:63], v142 offset:2560
    v_mfma_f32_16x16x32_bf16 v[52:55], a[8:11], a[28:31], v[52:55]
    ds_read_b128 a[40:43], v136 offset:4096
    v_mfma_f32_16x16x32_bf16 v[12:15], a[20:23], a[8:11], v[12:15]
    ds_read_b64_tr_b16 a[52:53], v142 offset:0
    v_mfma_f32_16x16x32_bf16 v[36:39], a[24:27], a[12:15], v[36:39]
    ds_read_b64_tr_b16 a[54:55], v142 offset:512
    s_waitcnt vmcnt(0)
    v_mfma_f32_16x16x32_bf16 v[56:59], a[12:15], a[28:31], v[56:59]
    ds_read_b128 a[44:47], v136 offset:6144
    v_mfma_f32_16x16x32_bf16 v[16:19], a[20:23], a[12:15], v[16:19]
    ds_read_b128 a[48:51], v136 offset:8192
    v_mfma_f32_16x16x32_bf16 v[40:43], a[24:27], a[16:19], v[40:43]
    s_cmp_lg_u32 s52, 3
    s_cbranch_scc1 L_32
    s_mov_b64 exec, 1
    buffer_atomic_add v5, v4, s[48:51], 0 offen sc1
    s_mov_b64 exec, -1
L_32:
    v_mfma_f32_16x16x32_bf16 v[60:63], a[16:19], a[28:31], v[60:63]
    v_mfma_f32_16x16x32_bf16 v[20:23], a[20:23], a[16:19], v[20:23]
    v_mfma_f32_16x16x32_bf16 v[104:107], a[20:23], a[64:67], v[104:107]
    s_cmp_lg_u32 s40, 0
    s_cbranch_scc1 L_33
    v_mfma_f32_16x16x32_bf16 v[64:67], a[0:3], a[0:3], v[64:67]
    v_mfma_f32_16x16x32_bf16 v[68:71], a[4:7], a[4:7], v[68:71]
    v_mfma_f32_16x16x32_bf16 v[72:75], a[8:11], a[8:11], v[72:75]
    v_mfma_f32_16x16x32_bf16 v[76:79], a[12:15], a[12:15], v[76:79]
    v_mfma_f32_16x16x32_bf16 v[80:83], a[16:19], a[16:19], v[80:83]
    s_branch L_34
L_33:
    v_mfma_f32_16x16x32_bf16 v[64:67], a[64:67], a[0:3], v[64:67]
    v_mfma_f32_16x16x32_bf16 v[68:71], a[64:67], a[4:7], v[68:71]
    v_mfma_f32_16x16x32_bf16 v[72:75], a[64:67], a[8:11], v[72:75]
    v_mfma_f32_16x16x32_bf16 v[76:79], a[64:67], a[12:15], v[76:79]
    v_mfma_f32_16x16x32_bf16 v[80:83], a[64:67], a[16:19], v[80:83]
L_34:
    s_waitcnt lgkmcnt(0)
    s_barrier
    v_mfma_f32_16x16x32_bf16 v[24:27], a[56:59], a[32:35], v[24:27]
    ds_read_b64_tr_b16 a[24:25], v140 offset:1024
    v_mfma_f32_16x16x32_bf16 v[44:47], a[32:35], a[60:63], v[44:47]
    ds_read_b64_tr_b16 a[26:27], v140 offset:1536
    v_mfma_f32_16x16x32_bf16 v[28:31], a[56:59], a[36:39], v[28:31]
    ds_read_b128 a[0:3], v134 offset:0
    v_mfma_f32_16x16x32_bf16 v[48:51], a[36:39], a[60:63], v[48:51]
    ds_read_b64_tr_b16 a[28:29], v140 offset:2048
    v_mfma_f32_16x16x32_bf16 v[8:11], a[52:55], a[36:39], v[8:11]
    ds_read_b128 a[4:7], v134 offset:2048
    v_mfma_f32_16x16x32_bf16 v[32:35], a[56:59], a[40:43], v[32:35]
    ds_read_b64_tr_b16 a[30:31], v140 offset:2560
    v_mfma_f32_16x16x32_bf16 v[52:55], a[40:43], a[60:63], v[52:55]
    ds_read_b128 a[8:11], v134 offset:4096
    v_mfma_f32_16x16x32_bf16 v[12:15], a[52:55], a[40:43], v[12:15]
    ds_read_b64_tr_b16 a[20:21], v140 offset:0
    v_mfma_f32_16x16x32_bf16 v[36:39], a[56:59], a[44:47], v[36:39]
    ds_read_b64_tr_b16 a[22:23], v140 offset:512
    v_mfma_f32_16x16x32_bf16 v[56:59], a[44:47], a[60:63], v[56:59]
    ds_read_b128 a[12:15], v134 offset:6144
    v_mfma_f32_16x16x32_bf16 v[16:19], a[52:55], a[44:47], v[16:19]
    ds_read_b128 a[16:19], v134 offset:8192
    v_mfma_f32_16x16x32_bf16 v[40:43], a[56:59], a[48:51], v[40:43]
    v_mfma_f32_16x16x32_bf16 v[60:63], a[48:51], a[60:63], v[60:63]
    v_mfma_f32_16x16x32_bf16 v[20:23], a[52:55], a[48:51], v[20:23]
    v_mfma_f32_16x16x32_bf16 v[104:107], a[52:55], a[64:67], v[104:107]
    s_waitcnt lgkmcnt(0)
    v_mfma_f32_16x16x32_bf16 v[24:27], a[24:27], a[0:3], v[24:27]
    ds_read_b64_tr_b16 a[56:57], v143 offset:1024
    v_mfma_f32_16x16x32_bf16 v[44:47], a[0:3], a[28:31], v[44:47]
    ds_read_b64_tr_b16 a[58:59], v143 offset:1536
    v_mfma_f32_16x16x32_bf16 v[28:31], a[24:27], a[4:7], v[28:31]
    ds_read_b128 a[32:35], v137 offset:0
    v_mfma_f32_16x16x32_bf16 v[48:51], a[4:7], a[28:31], v[48:51]
    ds_read_b64_tr_b16 a[60:61], v143 offset:2048
    v_mfma_f32_16x16x32_bf16 v[8:11], a[20:23], a[4:7], v[8:11]
    ds_read_b128 a[36:39], v137 offset:2048
    v_mfma_f32_16x16x32_bf16 v[32:35], a[24:27], a[8:11], v[32:35]
    ds_read_b64_tr_b16 a[62:63], v143 offset:2560
    v_mfma_f32_16x16x32_bf16 v[52:55], a[8:11], a[28:31], v[52:55]
    ds_read_b128 a[40:43], v137 offset:4096
    v_mfma_f32_16x16x32_bf16 v[12:15], a[20:23], a[8:11], v[12:15]
    ds_read_b64_tr_b16 a[52:53], v143 offset:0
    v_mfma_f32_16x16x32_bf16 v[36:39], a[24:27], a[12:15], v[36:39]
    ds_read_b64_tr_b16 a[54:55], v143 offset:512
    v_mfma_f32_16x16x32_bf16 v[56:59], a[12:15], a[28:31], v[56:59]
    ds_read_b128 a[44:47], v137 offset:6144
    v_mfma_f32_16x16x32_bf16 v[16:19], a[20:23], a[12:15], v[16:19]
    ds_read_b128 a[48:51], v137 offset:8192
    v_mfma_f32_16x16x32_bf16 v[40:43], a[24:27], a[16:19], v[40:43]
    v_mfma_f32_16x16x32_bf16 v[60:63], a[16:19], a[28:31], v[60:63]
    v_mfma_f32_16x16x32_bf16 v[20:23], a[20:23], a[16:19], v[20:23]
    v_mfma_f32_16x16x32_bf16 v[104:107], a[20:23], a[64:67], v[104:107]
    s_cmp_lg_u32 s40, 0
    s_cbranch_scc1 L_35
    v_mfma_f32_16x16x32_bf16 v[64:67], a[0:3], a[0:3], v[64:67]
    v_mfma_f32_16x16x32_bf16 v[68:71], a[4:7], a[4:7], v[68:71]
    v_mfma_f32_16x16x32_bf16 v[72:75], a[8:11], a[8:11], v[72:75]
    v_mfma_f32_16x16x32_bf16 v[76:79], a[12:15], a[12:15], v[76:79]
    v_mfma_f32_16x16x32_bf16 v[80:83], a[16:19], a[16:19], v[80:83]
    s_branch L_36
L_35:
    v_mfma_f32_16x16x32_bf16 v[64:67], a[64:67], a[0:3], v[64:67]
    v_mfma_f32_16x16x32_bf16 v[68:71], a[64:67], a[4:7], v[68:71]
    v_mfma_f32_16x16x32_bf16 v[72:75], a[64:67], a[8:11], v[72:75]
    v_mfma_f32_16x16x32_bf16 v[76:79], a[64:67], a[12:15], v[76:79]
    v_mfma_f32_16x16x32_bf16 v[80:83], a[64:67], a[16:19], v[80:83]
L_36:
    s_waitcnt lgkmcnt(0)
    s_barrier
    v_mfma_f32_16x16x32_bf16 v[24:27], a[56:59], a[32:35], v[24:27]
    ds_read_b64_tr_b16 a[24:25], v138 offset:1024
    v_mfma_f32_16x16x32_bf16 v[44:47], a[32:35], a[60:63], v[44:47]
    ds_read_b64_tr_b16 a[26:27], v138 offset:1536
    v_mfma_f32_16x16x32_bf16 v[28:31], a[56:59], a[36:39], v[28:31]
    ds_read_b128 a[0:3], v132 offset:0
    v_mfma_f32_16x16x32_bf16 v[48:51], a[36:39], a[60:63], v[48:51]
    ds_read_b64_tr_b16 a[28:29], v138 offset:2048
    v_mfma_f32_16x16x32_bf16 v[8:11], a[52:55], a[36:39], v[8:11]
    ds_read_b128 a[4:7], v132 offset:2048
    v_mfma_f32_16x16x32_bf16 v[32:35], a[56:59], a[40:43], v[32:35]
    ds_read_b64_tr_b16 a[30:31], v138 offset:2560
    v_mfma_f32_16x16x32_bf16 v[52:55], a[40:43], a[60:63], v[52:55]
    ds_read_b128 a[8:11], v132 offset:4096
    v_mfma_f32_16x16x32_bf16 v[12:15], a[52:55], a[40:43], v[12:15]
    ds_read_b64_tr_b16 a[20:21], v138 offset:0
    v_mfma_f32_16x16x32_bf16 v[36:39], a[56:59], a[44:47], v[36:39]
    ds_read_b64_tr_b16 a[22:23], v138 offset:512
    v_mfma_f32_16x16x32_bf16 v[56:59], a[44:47], a[60:63], v[56:59]
    ds_read_b128 a[12:15], v132 offset:6144
    v_mfma_f32_16x16x32_bf16 v[16:19], a[52:55], a[44:47], v[16:19]
    ds_read_b128 a[16:19], v132 offset:8192
    v_mfma_f32_16x16x32_bf16 v[40:43], a[56:59], a[48:51], v[40:43]
    v_mfma_f32_16x16x32_bf16 v[60:63], a[48:51], a[60:63], v[60:63]
    v_mfma_f32_16x16x32_bf16 v[20:23], a[52:55], a[48:51], v[20:23]
    v_mfma_f32_16x16x32_bf16 v[104:107], a[52:55], a[64:67], v[104:107]
    s_waitcnt lgkmcnt(0)
    v_mfma_f32_16x16x32_bf16 v[24:27], a[24:27], a[0:3], v[24:27]
    ds_read_b64_tr_b16 a[56:57], v141 offset:1024
    v_mfma_f32_16x16x32_bf16 v[44:47], a[0:3], a[28:31], v[44:47]
    ds_read_b64_tr_b16 a[58:59], v141 offset:1536
    v_mfma_f32_16x16x32_bf16 v[28:31], a[24:27], a[4:7], v[28:31]
    ds_read_b128 a[32:35], v135 offset:0
    v_mfma_f32_16x16x32_bf16 v[48:51], a[4:7], a[28:31], v[48:51]
    ds_read_b64_tr_b16 a[60:61], v141 offset:2048
    v_mfma_f32_16x16x32_bf16 v[8:11], a[20:23], a[4:7], v[8:11]
    ds_read_b128 a[36:39], v135 offset:2048
    v_mfma_f32_16x16x32_bf16 v[32:35], a[24:27], a[8:11], v[32:35]
    ds_read_b64_tr_b16 a[62:63], v141 offset:2560
    v_mfma_f32_16x16x32_bf16 v[52:55], a[8:11], a[28:31], v[52:55]
    ds_read_b128 a[40:43], v135 offset:4096
    v_mfma_f32_16x16x32_bf16 v[12:15], a[20:23], a[8:11], v[12:15]
    ds_read_b64_tr_b16 a[52:53], v141 offset:0
    v_mfma_f32_16x16x32_bf16 v[36:39], a[24:27], a[12:15], v[36:39]
    ds_read_b64_tr_b16 a[54:55], v141 offset:512
    v_mfma_f32_16x16x32_bf16 v[56:59], a[12:15], a[28:31], v[56:59]
    ds_read_b128 a[44:47], v135 offset:6144
    v_mfma_f32_16x16x32_bf16 v[16:19], a[20:23], a[12:15], v[16:19]
    ds_read_b128 a[48:51], v135 offset:8192
    v_mfma_f32_16x16x32_bf16 v[40:43], a[24:27], a[16:19], v[40:43]
    v_mfma_f32_16x16x32_bf16 v[60:63], a[16:19], a[28:31], v[60:63]
    v_mfma_f32_16x16x32_bf16 v[20:23], a[20:23], a[16:19], v[20:23]
    v_mfma_f32_16x16x32_bf16 v[104:107], a[20:23], a[64:67], v[104:107]
    s_cmp_lg_u32 s40, 0
    s_cbranch_scc1 L_37
    v_mfma_f32_16x16x32_bf16 v[64:67], a[0:3], a[0:3], v[64:67]
    v_mfma_f32_16x16x32_bf16 v[68:71], a[4:7], a[4:7], v[68:71]
    v_mfma_f32_16x16x32_bf16 v[72:75], a[8:11], a[8:11], v[72:75]
    v_mfma_f32_16x16x32_bf16 v[76:79], a[12:15], a[12:15], v[76:79]
    v_mfma_f32_16x16x32_bf16 v[80:83], a[16:19], a[16:19], v[80:83]
    s_branch L_38
L_37:
    v_mfma_f32_16x16x32_bf16 v[64:67], a[64:67], a[0:3], v[64:67]
    v_mfma_f32_16x16x32_bf16 v[68:71], a[64:67], a[4:7], v[68:71]
    v_mfma_f32_16x16x32_bf16 v[72:75], a[64:67], a[8:11], v[72:75]
    v_mfma_f32_16x16x32_bf16 v[76:79], a[64:67], a[12:15], v[76:79]
    v_mfma_f32_16x16x32_bf16 v[80:83], a[64:67], a[16:19], v[80:83]
L_38:
    s_waitcnt lgkmcnt(0)
    s_barrier
    v_mfma_f32_16x16x32_bf16 v[24:27], a[56:59], a[32:35], v[24:27]
    ds_read_b64_tr_b16 a[24:25], v139 offset:1024
    v_mfma_f32_16x16x32_bf16 v[44:47], a[32:35], a[60:63], v[44:47]
    ds_read_b64_tr_b16 a[26:27], v139 offset:1536
    v_mfma_f32_16x16x32_bf16 v[28:31], a[56:59], a[36:39], v[28:31]
    ds_read_b128 a[0:3], v133 offset:0
    v_mfma_f32_16x16x32_bf16 v[48:51], a[36:39], a[60:63], v[48:51]
    ds_read_b64_tr_b16 a[28:29], v139 offset:2048
    v_mfma_f32_16x16x32_bf16 v[8:11], a[52:55], a[36:39], v[8:11]
    ds_read_b128 a[4:7], v133 offset:2048
    v_mfma_f32_16x16x32_bf16 v[32:35], a[56:59], a[40:43], v[32:35]
    ds_read_b64_tr_b16 a[30:31], v139 offset:2560
    v_mfma_f32_16x16x32_bf16 v[52:55], a[40:43], a[60:63], v[52:55]
    ds_read_b128 a[8:11], v133 offset:4096
    v_mfma_f32_16x16x32_bf16 v[12:15], a[52:55], a[40:43], v[12:15]
    ds_read_b64_tr_b16 a[20:21], v139 offset:0
    v_mfma_f32_16x16x32_bf16 v[36:39], a[56:59], a[44:47], v[36:39]
    ds_read_b64_tr_b16 a[22:23], v139 offset:512
    v_mfma_f32_16x16x32_bf16 v[56:59], a[44:47], a[60:63], v[56:59]
    ds_read_b128 a[12:15], v133 offset:6144
    v_mfma_f32_16x16x32_bf16 v[16:19], a[52:55], a[44:47], v[16:19]
    ds_read_b128 a[16:19], v133 offset:8192
    v_mfma_f32_16x16x32_bf16 v[40:43], a[56:59], a[48:51], v[40:43]
    v_mfma_f32_16x16x32_bf16 v[60:63], a[48:51], a[60:63], v[60:63]
    v_mfma_f32_16x16x32_bf16 v[20:23], a[52:55], a[48:51], v[20:23]
    v_mfma_f32_16x16x32_bf16 v[104:107], a[52:55], a[64:67], v[104:107]
    s_waitcnt lgkmcnt(0)
    v_mfma_f32_16x16x32_bf16 v[24:27], a[24:27], a[0:3], v[24:27]
    ds_read_b64_tr_b16 a[56:57], v142 offset:1024
    v_mfma_f32_16x16x32_bf16 v[44:47], a[0:3], a[28:31], v[44:47]
    ds_read_b64_tr_b16 a[58:59], v142 offset:1536
    v_mfma_f32_16x16x32_bf16 v[28:31], a[24:27], a[4:7], v[28:31]
    ds_read_b128 a[32:35], v136 offset:0
    v_mfma_f32_16x16x32_bf16 v[48:51], a[4:7], a[28:31], v[48:51]
    ds_read_b64_tr_b16 a[60:61], v142 offset:2048
    v_mfma_f32_16x16x32_bf16 v[8:11], a[20:23], a[4:7], v[8:11]
    ds_read_b128 a[36:39], v136 offset:2048
    v_mfma_f32_16x16x32_bf16 v[32:35], a[24:27], a[8:11], v[32:35]
    ds_read_b64_tr_b16 a[62:63], v142 offset:2560
    v_mfma_f32_16x16x32_bf16 v[52:55], a[8:11], a[28:31], v[52:55]
    ds_read_b128 a[40:43], v136 offset:4096
    v_mfma_f32_16x16x32_bf16 v[12:15], a[20:23], a[8:11], v[12:15]
    ds_read_b64_tr_b16 a[52:53], v142 offset:0
    v_mfma_f32_16x16x32_bf16 v[36:39], a[24:27], a[12:15], v[36:39]
    ds_read_b64_tr_b16 a[54:55], v142 offset:512
    v_mfma_f32_16x16x32_bf16 v[56:59], a[12:15], a[28:31], v[56:59]
    ds_read_b128 a[44:47], v136 offset:6144
    v_mfma_f32_16x16x32_bf16 v[16:19], a[20:23], a[12:15], v[16:19]
    ds_read_b128 a[48:51], v136 offset:8192
    v_mfma_f32_16x16x32_bf16 v[40:43], a[24:27], a[16:19], v[40:43]
    v_mfma_f32_16x16x32_bf16 v[60:63], a[16:19], a[28:31], v[60:63]
    v_mfma_f32_16x16x32_bf16 v[20:23], a[20:23], a[16:19], v[20:23]
    v_mfma_f32_16x16x32_bf16 v[104:107], a[20:23], a[64:67], v[104:107]
    s_cmp_lg_u32 s40, 0
    s_cbranch_scc1 L_39
    v_mfma_f32_16x16x32_bf16 v[64:67], a[0:3], a[0:3], v[64:67]
    v_mfma_f32_16x16x32_bf16 v[68:71], a[4:7], a[4:7], v[68:71]
    v_mfma_f32_16x16x32_bf16 v[72:75], a[8:11], a[8:11], v[72:75]
    v_mfma_f32_16x16x32_bf16 v[76:79], a[12:15], a[12:15], v[76:79]
    v_mfma_f32_16x16x32_bf16 v[80:83], a[16:19], a[16:19], v[80:83]
    s_branch L_40
L_39:
    v_mfma_f32_16x16x32_bf16 v[64:67], a[64:67], a[0:3], v[64:67]
    v_mfma_f32_16x16x32_bf16 v[68:71], a[64:67], a[4:7], v[68:71]
    v_mfma_f32_16x16x32_bf16 v[72:75], a[64:67], a[8:11], v[72:75]
    v_mfma_f32_16x16x32_bf16 v[76:79], a[64:67], a[12:15], v[76:79]
    v_mfma_f32_16x16x32_bf16 v[80:83], a[64:67], a[16:19], v[80:83]
L_40:
    s_waitcnt lgkmcnt(0)
    s_barrier
    v_mfma_f32_16x16x32_bf16 v[24:27], a[56:59], a[32:35], v[24:27]
    ds_read_b64_tr_b16 a[24:25], v140 offset:1024
    v_mfma_f32_16x16x32_bf16 v[44:47], a[32:35], a[60:63], v[44:47]
    ds_read_b64_tr_b16 a[26:27], v140 offset:1536
    v_mfma_f32_16x16x32_bf16 v[28:31], a[56:59], a[36:39], v[28:31]
    ds_read_b128 a[0:3], v134 offset:0
    v_mfma_f32_16x16x32_bf16 v[48:51], a[36:39], a[60:63], v[48:51]
    ds_read_b64_tr_b16 a[28:29], v140 offset:2048
    v_mfma_f32_16x16x32_bf16 v[8:11], a[52:55], a[36:39], v[8:11]
    ds_read_b128 a[4:7], v134 offset:2048
    v_mfma_f32_16x16x32_bf16 v[32:35], a[56:59], a[40:43], v[32:35]
    ds_read_b64_tr_b16 a[30:31], v140 offset:2560
    v_mfma_f32_16x16x32_bf16 v[52:55], a[40:43], a[60:63], v[52:55]
    ds_read_b128 a[8:11], v134 offset:4096
    v_mfma_f32_16x16x32_bf16 v[12:15], a[52:55], a[40:43], v[12:15]
    ds_read_b64_tr_b16 a[20:21], v140 offset:0
    v_mfma_f32_16x16x32_bf16 v[36:39], a[56:59], a[44:47], v[36:39]
    ds_read_b64_tr_b16 a[22:23], v140 offset:512
    v_mfma_f32_16x16x32_bf16 v[56:59], a[44:47], a[60:63], v[56:59]
    ds_read_b128 a[12:15], v134 offset:6144
    v_mfma_f32_16x16x32_bf16 v[16:19], a[52:55], a[44:47], v[16:19]
    ds_read_b128 a[16:19], v134 offset:8192
    v_mfma_f32_16x16x32_bf16 v[40:43], a[56:59], a[48:51], v[40:43]
    v_mfma_f32_16x16x32_bf16 v[60:63], a[48:51], a[60:63], v[60:63]
    v_mfma_f32_16x16x32_bf16 v[20:23], a[52:55], a[48:51], v[20:23]
    v_mfma_f32_16x16x32_bf16 v[104:107], a[52:55], a[64:67], v[104:107]
    s_waitcnt lgkmcnt(0)
    v_mfma_f32_16x16x32_bf16 v[24:27], a[24:27], a[0:3], v[24:27]
    ds_read_b64_tr_b16 a[56:57], v143 offset:1024
    v_mfma_f32_16x16x32_bf16 v[44:47], a[0:3], a[28:31], v[44:47]
    ds_read_b64_tr_b16 a[58:59], v143 offset:1536
    v_mfma_f32_16x16x32_bf16 v[28:31], a[24:27], a[4:7], v[28:31]
    ds_read_b128 a[32:35], v137 offset:0
    v_mfma_f32_16x16x32_bf16 v[48:51], a[4:7], a[28:31], v[48:51]
    ds_read_b64_tr_b16 a[60:61], v143 offset:2048
    v_mfma_f32_16x16x32_bf16 v[8:11], a[20:23], a[4:7], v[8:11]
    ds_read_b128 a[36:39], v137 offset:2048
    v_mfma_f32_16x16x32_bf16 v[32:35], a[24:27], a[8:11], v[32:35]
    ds_read_b64_tr_b16 a[62:63], v143 offset:2560
    v_mfma_f32_16x16x32_bf16 v[52:55], a[8:11], a[28:31], v[52:55]
    ds_read_b128 a[40:43], v137 offset:4096
    v_mfma_f32_16x16x32_bf16 v[12:15], a[20:23], a[8:11], v[12:15]
    ds_read_b64_tr_b16 a[52:53], v143 offset:0
    v_mfma_f32_16x16x32_bf16 v[36:39], a[24:27], a[12:15], v[36:39]
    ds_read_b64_tr_b16 a[54:55], v143 offset:512
    v_mfma_f32_16x16x32_bf16 v[56:59], a[12:15], a[28:31], v[56:59]
    ds_read_b128 a[44:47], v137 offset:6144
    v_mfma_f32_16x16x32_bf16 v[16:19], a[20:23], a[12:15], v[16:19]
    ds_read_b128 a[48:51], v137 offset:8192
    v_mfma_f32_16x16x32_bf16 v[40:43], a[24:27], a[16:19], v[40:43]
    v_mfma_f32_16x16x32_bf16 v[60:63], a[16:19], a[28:31], v[60:63]
    v_mfma_f32_16x16x32_bf16 v[20:23], a[20:23], a[16:19], v[20:23]
    v_mfma_f32_16x16x32_bf16 v[104:107], a[20:23], a[64:67], v[104:107]
    s_cmp_lg_u32 s40, 0
    s_cbranch_scc1 L_41
    v_mfma_f32_16x16x32_bf16 v[64:67], a[0:3], a[0:3], v[64:67]
    v_mfma_f32_16x16x32_bf16 v[68:71], a[4:7], a[4:7], v[68:71]
    v_mfma_f32_16x16x32_bf16 v[72:75], a[8:11], a[8:11], v[72:75]
    v_mfma_f32_16x16x32_bf16 v[76:79], a[12:15], a[12:15], v[76:79]
    v_mfma_f32_16x16x32_bf16 v[80:83], a[16:19], a[16:19], v[80:83]
    s_branch L_42
L_41:
    v_mfma_f32_16x16x32_bf16 v[64:67], a[64:67], a[0:3], v[64:67]
    v_mfma_f32_16x16x32_bf16 v[68:71], a[64:67], a[4:7], v[68:71]
    v_mfma_f32_16x16x32_bf16 v[72:75], a[64:67], a[8:11], v[72:75]
    v_mfma_f32_16x16x32_bf16 v[76:79], a[64:67], a[12:15], v[76:79]
    v_mfma_f32_16x16x32_bf16 v[80:83], a[64:67], a[16:19], v[80:83]
L_42:
    s_waitcnt lgkmcnt(0)
    s_barrier
    v_mfma_f32_16x16x32_bf16 v[24:27], a[56:59], a[32:35], v[24:27]
    ds_read_b64_tr_b16 a[24:25], v138 offset:1024
    v_mfma_f32_16x16x32_bf16 v[44:47], a[32:35], a[60:63], v[44:47]
    ds_read_b64_tr_b16 a[26:27], v138 offset:1536
    v_mfma_f32_16x16x32_bf16 v[28:31], a[56:59], a[36:39], v[28:31]
    ds_read_b128 a[0:3], v132 offset:0
    v_mfma_f32_16x16x32_bf16 v[48:51], a[36:39], a[60:63], v[48:51]
    ds_read_b64_tr_b16 a[28:29], v138 offset:2048
    v_mfma_f32_16x16x32_bf16 v[8:11], a[52:55], a[36:39], v[8:11]
    ds_read_b128 a[4:7], v132 offset:2048
    v_mfma_f32_16x16x32_bf16 v[32:35], a[56:59], a[40:43], v[32:35]
    ds_read_b64_tr_b16 a[30:31], v138 offset:2560
    v_mfma_f32_16x16x32_bf16 v[52:55], a[40:43], a[60:63], v[52:55]
    ds_read_b128 a[8:11], v132 offset:4096
    v_mfma_f32_16x16x32_bf16 v[12:15], a[52:55], a[40:43], v[12:15]
    ds_read_b64_tr_b16 a[20:21], v138 offset:0
    v_mfma_f32_16x16x32_bf16 v[36:39], a[56:59], a[44:47], v[36:39]
    ds_read_b64_tr_b16 a[22:23], v138 offset:512
    v_mfma_f32_16x16x32_bf16 v[56:59], a[44:47], a[60:63], v[56:59]
    ds_read_b128 a[12:15], v132 offset:6144
    v_mfma_f32_16x16x32_bf16 v[16:19], a[52:55], a[44:47], v[16:19]
    ds_read_b128 a[16:19], v132 offset:8192
    v_mfma_f32_16x16x32_bf16 v[40:43], a[56:59], a[48:51], v[40:43]
    v_mfma_f32_16x16x32_bf16 v[60:63], a[48:51], a[60:63], v[60:63]
    v_mfma_f32_16x16x32_bf16 v[20:23], a[52:55], a[48:51], v[20:23]
    v_mfma_f32_16x16x32_bf16 v[104:107], a[52:55], a[64:67], v[104:107]
    s_waitcnt lgkmcnt(0)
    v_mfma_f32_16x16x32_bf16 v[24:27], a[24:27], a[0:3], v[24:27]
    ds_read_b64_tr_b16 a[56:57], v141 offset:1024
    v_mfma_f32_16x16x32_bf16 v[44:47], a[0:3], a[28:31], v[44:47]
    ds_read_b64_tr_b16 a[58:59], v141 offset:1536
    v_mfma_f32_16x16x32_bf16 v[28:31], a[24:27], a[4:7], v[28:31]
    ds_read_b128 a[32:35], v135 offset:0
    v_mfma_f32_16x16x32_bf16 v[48:51], a[4:7], a[28:31], v[48:51]
    ds_read_b64_tr_b16 a[60:61], v141 offset:2048
    v_mfma_f32_16x16x32_bf16 v[8:11], a[20:23], a[4:7], v[8:11]
    ds_read_b128 a[36:39], v135 offset:2048
    v_mfma_f32_16x16x32_bf16 v[32:35], a[24:27], a[8:11], v[32:35]
    ds_read_b64_tr_b16 a[62:63], v141 offset:2560
    v_mfma_f32_16x16x32_bf16 v[52:55], a[8:11], a[28:31], v[52:55]
    ds_read_b128 a[40:43], v135 offset:4096
    v_mfma_f32_16x16x32_bf16 v[12:15], a[20:23], a[8:11], v[12:15]
    ds_read_b64_tr_b16 a[52:53], v141 offset:0
    v_mfma_f32_16x16x32_bf16 v[36:39], a[24:27], a[12:15], v[36:39]
    ds_read_b64_tr_b16 a[54:55], v141 offset:512
    v_mfma_f32_16x16x32_bf16 v[56:59], a[12:15], a[28:31], v[56:59]
    ds_read_b128 a[44:47], v135 offset:6144
    v_mfma_f32_16x16x32_bf16 v[16:19], a[20:23], a[12:15], v[16:19]
    ds_read_b128 a[48:51], v135 offset:8192
    v_mfma_f32_16x16x32_bf16 v[40:43], a[24:27], a[16:19], v[40:43]
    v_mfma_f32_16x16x32_bf16 v[60:63], a[16:19], a[28:31], v[60:63]
    v_mfma_f32_16x16x32_bf16 v[20:23], a[20:23], a[16:19], v[20:23]
    v_mfma_f32_16x16x32_bf16 v[104:107], a[20:23], a[64:67], v[104:107]
    s_cmp_lg_u32 s40, 0
    s_cbranch_scc1 L_43
    v_mfma_f32_16x16x32_bf16 v[64:67], a[0:3], a[0:3], v[64:67]
    v_mfma_f32_16x16x32_bf16 v[68:71], a[4:7], a[4:7], v[68:71]
    v_mfma_f32_16x16x32_bf16 v[72:75], a[8:11], a[8:11], v[72:75]
    v_mfma_f32_16x16x32_bf16 v[76:79], a[12:15], a[12:15], v[76:79]
    v_mfma_f32_16x16x32_bf16 v[80:83], a[16:19], a[16:19], v[80:83]
    s_branch L_44
L_43:
    v_mfma_f32_16x16x32_bf16 v[64:67], a[64:67], a[0:3], v[64:67]
    v_mfma_f32_16x16x32_bf16 v[68:71], a[64:67], a[4:7], v[68:71]
    v_mfma_f32_16x16x32_bf16 v[72:75], a[64:67], a[8:11], v[72:75]
    v_mfma_f32_16x16x32_bf16 v[76:79], a[64:67], a[12:15], v[76:79]
    v_mfma_f32_16x16x32_bf16 v[80:83], a[64:67], a[16:19], v[80:83]
L_44:
    s_waitcnt lgkmcnt(0)
    s_barrier
    v_mfma_f32_16x16x32_bf16 v[24:27], a[56:59], a[32:35], v[24:27]
    ds_read_b64_tr_b16 a[24:25], v139 offset:1024
    v_mfma_f32_16x16x32_bf16 v[44:47], a[32:35], a[60:63], v[44:47]
    ds_read_b64_tr_b16 a[26:27], v139 offset:1536
    v_mfma_f32_16x16x32_bf16 v[28:31], a[56:59], a[36:39], v[28:31]
    ds_read_b128 a[0:3], v133 offset:0
    v_mfma_f32_16x16x32_bf16 v[48:51], a[36:39], a[60:63], v[48:51]
    ds_read_b64_tr_b16 a[28:29], v139 offset:2048
    v_mfma_f32_16x16x32_bf16 v[8:11], a[52:55], a[36:39], v[8:11]
    ds_read_b128 a[4:7], v133 offset:2048
    v_mfma_f32_16x16x32_bf16 v[32:35], a[56:59], a[40:43], v[32:35]
    ds_read_b64_tr_b16 a[30:31], v139 offset:2560
    v_mfma_f32_16x16x32_bf16 v[52:55], a[40:43], a[60:63], v[52:55]
    ds_read_b128 a[8:11], v133 offset:4096
    v_mfma_f32_16x16x32_bf16 v[12:15], a[52:55], a[40:43], v[12:15]
    ds_read_b64_tr_b16 a[20:21], v139 offset:0
    v_mfma_f32_16x16x32_bf16 v[36:39], a[56:59], a[44:47], v[36:39]
    ds_read_b64_tr_b16 a[22:23], v139 offset:512
    v_mfma_f32_16x16x32_bf16 v[56:59], a[44:47], a[60:63], v[56:59]
    ds_read_b128 a[12:15], v133 offset:6144
    v_mfma_f32_16x16x32_bf16 v[16:19], a[52:55], a[44:47], v[16:19]
    ds_read_b128 a[16:19], v133 offset:8192
    v_mfma_f32_16x16x32_bf16 v[40:43], a[56:59], a[48:51], v[40:43]
    v_mfma_f32_16x16x32_bf16 v[60:63], a[48:51], a[60:63], v[60:63]
    v_mfma_f32_16x16x32_bf16 v[20:23], a[52:55], a[48:51], v[20:23]
    v_mfma_f32_16x16x32_bf16 v[104:107], a[52:55], a[64:67], v[104:107]
    s_waitcnt lgkmcnt(0)
    s_cmp_lg_u32 s40, 0
    s_cbranch_scc1 L_45
    v_mfma_f32_16x16x32_bf16 v[64:67], a[0:3], a[0:3], v[64:67]
    v_mfma_f32_16x16x32_bf16 v[68:71], a[4:7], a[4:7], v[68:71]
    v_mfma_f32_16x16x32_bf16 v[72:75], a[8:11], a[8:11], v[72:75]
    v_mfma_f32_16x16x32_bf16 v[76:79], a[12:15], a[12:15], v[76:79]
    v_mfma_f32_16x16x32_bf16 v[80:83], a[16:19], a[16:19], v[80:83]
    s_branch L_46
L_45:
    v_mfma_f32_16x16x32_bf16 v[64:67], a[64:67], a[0:3], v[64:67]
    v_mfma_f32_16x16x32_bf16 v[68:71], a[64:67], a[4:7], v[68:71]
    v_mfma_f32_16x16x32_bf16 v[72:75], a[64:67], a[8:11], v[72:75]
    v_mfma_f32_16x16x32_bf16 v[76:79], a[64:67], a[12:15], v[76:79]
    v_mfma_f32_16x16x32_bf16 v[80:83], a[64:67], a[16:19], v[80:83]
L_46:
    v_mfma_f32_16x16x32_bf16 v[24:27], a[24:27], a[0:3], v[24:27]
    ds_read_b64_tr_b16 a[56:57], v142 offset:1024
    ds_read_b64_tr_b16 a[58:59], v142 offset:1536
    v_mfma_f32_16x16x32_bf16 v[44:47], a[0:3], a[28:31], v[44:47]
    ds_read_b128 a[32:35], v136 offset:0
    v_mfma_f32_16x16x32_bf16 v[28:31], a[24:27], a[4:7], v[28:31]
    ds_read_b64_tr_b16 a[60:61], v142 offset:2048
    v_mfma_f32_16x16x32_bf16 v[48:51], a[4:7], a[28:31], v[48:51]
    ds_read_b128 a[36:39], v136 offset:2048
    v_cndmask_b32_e64 v64, v64, v65, s[64:65]
    v_cndmask_b32_e64 v64, v64, v66, s[66:67]
    v_mfma_f32_16x16x32_bf16 v[8:11], a[20:23], a[4:7], v[8:11]
    ds_read_b64_tr_b16 a[62:63], v142 offset:2560
    v_cndmask_b32_e64 v64, v64, v67, s[68:69]
    ds_write_b32 v165, v64 offset:0
    v_mfma_f32_16x16x32_bf16 v[32:35], a[24:27], a[8:11], v[32:35]
    ds_read_b128 a[40:43], v136 offset:4096
    v_cndmask_b32_e64 v68, v68, v69, s[64:65]
    v_mfma_f32_16x16x32_bf16 v[52:55], a[8:11], a[28:31], v[52:55]
    ds_read_b64_tr_b16 a[52:53], v142 offset:0
    v_cndmask_b32_e64 v68, v68, v70, s[66:67]
    v_cndmask_b32_e64 v68, v68, v71, s[68:69]
    v_mfma_f32_16x16x32_bf16 v[12:15], a[20:23], a[8:11], v[12:15]
    ds_read_b64_tr_b16 a[54:55], v142 offset:512
    ds_write_b32 v165, v68 offset:256
    v_cndmask_b32_e64 v72, v72, v73, s[64:65]
    v_mfma_f32_16x16x32_bf16 v[36:39], a[24:27], a[12:15], v[36:39]
    ds_read_b128 a[44:47], v136 offset:6144
    v_cndmask_b32_e64 v72, v72, v74, s[66:67]
    v_mfma_f32_16x16x32_bf16 v[56:59], a[12:15], a[28:31], v[56:59]
    ds_read_b128 a[48:51], v136 offset:8192
    v_cndmask_b32_e64 v72, v72, v75, s[68:69]
    ds_write_b32 v165, v72 offset:512
    v_mfma_f32_16x16x32_bf16 v[16:19], a[20:23], a[12:15], v[16:19]
    v_cndmask_b32_e64 v76, v76, v77, s[64:65]
    v_cndmask_b32_e64 v76, v76, v78, s[66:67]
    v_mfma_f32_16x16x32_bf16 v[40:43], a[24:27], a[16:19], v[40:43]
    v_cndmask_b32_e64 v76, v76, v79, s[68:69]
    v_mfma_f32_16x16x32_bf16 v[60:63], a[16:19], a[28:31], v[60:63]
    ds_write_b32 v165, v76 offset:768
    v_cndmask_b32_e64 v80, v80, v81, s[64:65]
    v_mfma_f32_16x16x32_bf16 v[20:23], a[20:23], a[16:19], v[20:23]
    v_cndmask_b32_e64 v80, v80, v82, s[66:67]
    v_cndmask_b32_e64 v80, v80, v83, s[68:69]
    v_mfma_f32_16x16x32_bf16 v[104:107], a[20:23], a[64:67], v[104:107]
    ds_write_b32 v165, v80 offset:1024
    s_waitcnt lgkmcnt(0)
    s_barrier
    v_mfma_f32_16x16x32_bf16 v[24:27], a[56:59], a[32:35], v[24:27]
    ds_read_b128 v[154:157], v166
    ds_read_b128 v[158:161], v167 offset:1024
    v_mfma_f32_16x16x32_bf16 v[44:47], a[32:35], a[60:63], v[44:47]
    v_mfma_f32_16x16x32_bf16 v[28:31], a[56:59], a[36:39], v[28:31]
    v_mfma_f32_16x16x32_bf16 v[48:51], a[36:39], a[60:63], v[48:51]
    v_mfma_f32_16x16x32_bf16 v[8:11], a[52:55], a[36:39], v[8:11]
    v_mfma_f32_16x16x32_bf16 v[32:35], a[56:59], a[40:43], v[32:35]
    s_waitcnt lgkmcnt(0)
    v_add_f32 v156, v156, v157
    v_add_f32 v155, v154, v155
    v_mfma_f32_16x16x32_bf16 v[52:55], a[40:43], a[60:63], v[52:55]
    v_add_f32 v160, v160, v161
    v_add_f32 v159, v158, v159
    v_mul_f32 v154, 0xbb000000, v156
    v_mfma_f32_16x16x32_bf16 v[12:15], a[52:55], a[40:43], v[12:15]
    v_mul_f32 v158, 0xbb000000, v160
    v_mul_f32 v156, v154, v154
    v_mul_f32 v160, v158, v158
    v_mfma_f32_16x16x32_bf16 v[36:39], a[56:59], a[44:47], v[36:39]
    v_fma_f32 v155, v155, s70, -v156
    v_fma_f32 v159, v159, s70, -v160
    v_max_f32 v155, 0, v155
    v_mfma_f32_16x16x32_bf16 v[56:59], a[44:47], a[60:63], v[56:59]
    v_max_f32 v159, 0, v159
    v_add_f32 v155, 0x3727c5ac, v155
    v_add_f32 v159, 0x3727c5ac, v159
    v_mfma_f32_16x16x32_bf16 v[16:19], a[52:55], a[44:47], v[16:19]
    v_rsq_f32 v155, v155
    v_rsq_f32 v159, v159
    ds_write_b32 v168, v154
    v_mfma_f32_16x16x32_bf16 v[40:43], a[56:59], a[48:51], v[40:43]
    ds_write_b32 v169, v158 offset:256
    ds_write_b32 v168, v155 offset:320
    ds_write_b32 v169, v159 offset:576
    v_mfma_f32_16x16x32_bf16 v[60:63], a[48:51], a[60:63], v[60:63]
    ds_read2_b32 v[144:145], v169 offset0:0 offset1:80
    ds_read2_b32 v[146:147], v169 offset0:16 offset1:96
    ds_read2_b32 v[148:149], v169 offset0:32 offset1:112
    v_mfma_f32_16x16x32_bf16 v[20:23], a[52:55], a[48:51], v[20:23]
    ds_read2_b32 v[150:151], v169 offset0:48 offset1:128
    ds_read2_b32 v[152:153], v169 offset0:64 offset1:144
    ds_read_b128 v[64:67], v170 offset:0
    v_mfma_f32_16x16x32_bf16 v[104:107], a[52:55], a[64:67], v[104:107]
    ds_read_b128 v[84:87], v170 offset:320
    ds_read_b128 v[68:71], v170 offset:64
    ds_read_b128 v[88:91], v170 offset:384
    ds_read_b128 v[72:75], v170 offset:128
    ds_read_b128 v[92:95], v170 offset:448
    ds_read_b128 v[76:79], v170 offset:192
    ds_read_b128 v[96:99], v170 offset:512
    ds_read_b128 v[80:83], v170 offset:256
    ds_read_b128 v[100:103], v170 offset:576
    s_setprio 3
    v_mov_b32_dpp v108, v24 row_newbcast:0 row_mask:0xf bank_mask:0xf
    v_mov_b32_dpp v109, v25 row_newbcast:0 row_mask:0xf bank_mask:0xf
    v_mov_b32_dpp v110, v26 row_newbcast:0 row_mask:0xf bank_mask:0xf
    v_mov_b32_dpp v111, v27 row_newbcast:0 row_mask:0xf bank_mask:0xf
    v_mov_b32 v112, v44
    v_mov_b32 v113, v44
    s_nop 1
    v_permlane16_swap_b32 v112, v113
    v_mov_b32 v113, v112
    s_nop 1
    v_permlane32_swap_b32 v112, v113
    s_waitcnt lgkmcnt(10)
    v_pk_fma_f32 v[24:25], v[108:109], v[144:145], v[24:25] op_sel_hi:[1,0,1]
    v_pk_fma_f32 v[26:27], v[110:111], v[144:145], v[26:27] op_sel_hi:[1,0,1]
    v_pk_mul_f32 v[24:25], v[24:25], v[144:145] op_sel:[0,1] op_sel_hi:[1,1]
    v_pk_mul_f32 v[26:27], v[26:27], v[144:145] op_sel:[0,1] op_sel_hi:[1,1]
    v_cvt_pk_bf16_f32 v24, v24, v25
    v_cvt_pk_bf16_f32 v25, v26, v27
    v_pk_fma_f32 v[28:29], v[108:109], v[146:147], v[28:29] op_sel_hi:[1,0,1]
    v_pk_fma_f32 v[30:31], v[110:111], v[146:147], v[30:31] op_sel_hi:[1,0,1]
    v_pk_fma_f32 v[8:9], v[104:105], v[146:147], v[8:9] op_sel_hi:[1,0,1]
    v_pk_fma_f32 v[10:11], v[106:107], v[146:147], v[10:11] op_sel_hi:[1,0,1]
    v_pk_mul_f32 v[28:29], v[28:29], v[146:147] op_sel:[0,1] op_sel_hi:[1,1]
    v_pk_mul_f32 v[30:31], v[30:31], v[146:147] op_sel:[0,1] op_sel_hi:[1,1]
    v_cvt_pk_bf16_f32 v8, v8, v9
    v_cvt_pk_bf16_f32 v9, v10, v11
    v_cvt_pk_bf16_f32 v28, v28, v29
    v_cvt_pk_bf16_f32 v29, v30, v31
    v_pk_fma_f32 v[32:33], v[108:109], v[148:149], v[32:33] op_sel_hi:[1,0,1]
    v_pk_fma_f32 v[34:35], v[110:111], v[148:149], v[34:35] op_sel_hi:[1,0,1]
    v_pk_fma_f32 v[12:13], v[104:105], v[148:149], v[12:13] op_sel_hi:[1,0,1]
    v_pk_fma_f32 v[14:15], v[106:107], v[148:149], v[14:15] op_sel_hi:[1,0,1]
    v_pk_mul_f32 v[32:33], v[32:33], v[148:149] op_sel:[0,1] op_sel_hi:[1,1]
    v_pk_mul_f32 v[34:35], v[34:35], v[148:149] op_sel:[0,1] op_sel_hi:[1,1]
    v_cvt_pk_bf16_f32 v12, v12, v13
    v_cvt_pk_bf16_f32 v13, v14, v15
    v_cvt_pk_bf16_f32 v32, v32, v33
    v_cvt_pk_bf16_f32 v33, v34, v35
    v_pk_fma_f32 v[36:37], v[108:109], v[150:151], v[36:37] op_sel_hi:[1,0,1]
    v_pk_fma_f32 v[38:39], v[110:111], v[150:151], v[38:39] op_sel_hi:[1,0,1]
    v_pk_fma_f32 v[16:17], v[104:105], v[150:151], v[16:17] op_sel_hi:[1,0,1]
    v_pk_fma_f32 v[18:19], v[106:107], v[150:151], v[18:19] op_sel_hi:[1,0,1]
    v_pk_mul_f32 v[36:37], v[36:37], v[150:151] op_sel:[0,1] op_sel_hi:[1,1]
    v_pk_mul_f32 v[38:39], v[38:39], v[150:151] op_sel:[0,1] op_sel_hi:[1,1]
    v_cvt_pk_bf16_f32 v16, v16, v17
    v_cvt_pk_bf16_f32 v17, v18, v19
    v_cvt_pk_bf16_f32 v36, v36, v37
    v_cvt_pk_bf16_f32 v37, v38, v39
    v_pk_fma_f32 v[40:41], v[108:109], v[152:153], v[40:41] op_sel_hi:[1,0,1]
    v_pk_fma_f32 v[42:43], v[110:111], v[152:153], v[42:43] op_sel_hi:[1,0,1]
    v_pk_fma_f32 v[20:21], v[104:105], v[152:153], v[20:21] op_sel_hi:[1,0,1]
    v_pk_fma_f32 v[22:23], v[106:107], v[152:153], v[22:23] op_sel_hi:[1,0,1]
    v_pk_mul_f32 v[40:41], v[40:41], v[152:153] op_sel:[0,1] op_sel_hi:[1,1]
    v_pk_mul_f32 v[42:43], v[42:43], v[152:153] op_sel:[0,1] op_sel_hi:[1,1]
    v_cvt_pk_bf16_f32 v20, v20, v21
    v_cvt_pk_bf16_f32 v21, v22, v23
    v_cvt_pk_bf16_f32 v40, v40, v41
    v_cvt_pk_bf16_f32 v41, v42, v43
    s_waitcnt lgkmcnt(0)
    v_pk_fma_f32 v[44:45], v[64:65], v[112:113], v[44:45] op_sel_hi:[1,0,1]
    v_pk_fma_f32 v[46:47], v[66:67], v[112:113], v[46:47] op_sel_hi:[1,0,1]
    v_pk_mul_f32 v[44:45], v[44:45], v[84:85]
    v_pk_mul_f32 v[46:47], v[46:47], v[86:87]
    v_pk_fma_f32 v[48:49], v[68:69], v[112:113], v[48:49] op_sel_hi:[1,0,1]
    v_pk_fma_f32 v[50:51], v[70:71], v[112:113], v[50:51] op_sel_hi:[1,0,1]
    v_pk_mul_f32 v[48:49], v[48:49], v[88:89]
    v_pk_mul_f32 v[50:51], v[50:51], v[90:91]
    v_pk_fma_f32 v[52:53], v[72:73], v[112:113], v[52:53] op_sel_hi:[1,0,1]
    v_pk_fma_f32 v[54:55], v[74:75], v[112:113], v[54:55] op_sel_hi:[1,0,1]
    v_pk_mul_f32 v[52:53], v[52:53], v[92:93]
    v_pk_mul_f32 v[54:55], v[54:55], v[94:95]
    v_pk_fma_f32 v[56:57], v[76:77], v[112:113], v[56:57] op_sel_hi:[1,0,1]
    v_pk_fma_f32 v[58:59], v[78:79], v[112:113], v[58:59] op_sel_hi:[1,0,1]
    v_pk_mul_f32 v[56:57], v[56:57], v[96:97]
    v_pk_mul_f32 v[58:59], v[58:59], v[98:99]
    v_pk_fma_f32 v[60:61], v[80:81], v[112:113], v[60:61] op_sel_hi:[1,0,1]
    v_pk_fma_f32 v[62:63], v[82:83], v[112:113], v[62:63] op_sel_hi:[1,0,1]
    v_pk_mul_f32 v[60:61], v[60:61], v[100:101]
    v_pk_mul_f32 v[62:63], v[62:63], v[102:103]
    v_mfma_f32_16x16x16_bf16 v[64:67], v[24:25], v[8:9], v[124:127]
    v_mul_f32 v128, 0x3eb8aa3b, v147
    v_mul_f32 v130, 0x3eb8aa3b, v149
    v_mfma_f32_16x16x16_bf16 v[84:87], v[28:29], v[8:9], v[116:119]
    v_mul_f32 v132, 0x3eb8aa3b, v151
    v_mul_f32 v134, 0x3eb8aa3b, v153
    v_mfma_f32_16x16x16_bf16 v[68:71], v[28:29], v[12:13], v[120:123]
    v_cvt_pk_bf16_f32 v154, v44, v45
    v_cvt_pk_bf16_f32 v155, v46, v47
    v_mfma_f32_16x16x16_bf16 v[88:91], v[32:33], v[12:13], v[116:119]
    v_cvt_pk_bf16_f32 v156, v48, v49
    v_cvt_pk_bf16_f32 v157, v50, v51
    v_mfma_f32_16x16x16_bf16 v[72:75], v[32:33], v[16:17], v[120:123]
    v_cvt_pk_bf16_f32 v158, v52, v53
    v_cvt_pk_bf16_f32 v159, v54, v55
    v_mfma_f32_16x16x16_bf16 v[92:95], v[36:37], v[16:17], v[116:119]
    v_cvt_pk_bf16_f32 v160, v56, v57
    v_cvt_pk_bf16_f32 v161, v58, v59
    v_mfma_f32_16x16x16_bf16 v[76:79], v[36:37], v[20:21], v[120:123]
    v_cvt_pk_bf16_f32 v162, v60, v61
    v_cvt_pk_bf16_f32 v163, v62, v63
    v_mfma_f32_16x16x16_bf16 v[96:99], v[40:41], v[20:21], v[116:119]
    v_accvgpr_read_b32 v104, a68
    v_accvgpr_read_b32 v105, a69
    v_accvgpr_read_b32 v106, a70
    v_accvgpr_read_b32 v107, a71
    v_max3_f32 v64, v64, v65, v84
    v_max3_f32 v66, v66, v67, v86
    v_max3_f32 v68, v68, v69, v88
    v_max3_f32 v70, v70, v71, v90
    v_max3_f32 v72, v72, v73, v92
    v_max3_f32 v74, v74, v75, v94
    v_max3_f32 v76, v76, v77, v96
    v_max3_f32 v78, v78, v79, v98
    v_max_f32 v64, v64, v85
    v_max_f32 v65, v66, v87
    v_max_f32 v68, v68, v89
    v_max_f32 v69, v70, v91
    v_max_f32 v72, v72, v93
    v_max_f32 v73, v74, v95
    v_max_f32 v76, v76, v97
    v_max_f32 v77, v78, v99
    v_max_f32 v136, v64, v65
    v_max_f32 v137, v68, v69
    v_max_f32 v138, v72, v73
    v_max_f32 v139, v76, v77
    v_mov_b32 v140, v136
    v_mov_b32 v141, v137
    v_mov_b32 v142, v138
    v_mov_b32 v143, v139
    v_permlane16_swap_b32 v136, v140
    v_permlane16_swap_b32 v137, v141
    v_permlane16_swap_b32 v138, v142
    v_permlane16_swap_b32 v139, v143
    v_max_f32 v136, v136, v140
    v_max_f32 v137, v137, v141
    v_max_f32 v138, v138, v142
    v_max_f32 v139, v139, v143
    v_mov_b32 v140, v136
    v_mov_b32 v141, v137
    v_mov_b32 v142, v138
    v_mov_b32 v143, v139
    v_permlane32_swap_b32 v136, v140
    v_permlane32_swap_b32 v137, v141
    v_permlane32_swap_b32 v138, v142
    v_permlane32_swap_b32 v139, v143
    v_max_f32 v136, v136, v140
    v_max_f32 v137, v137, v141
    v_max_f32 v138, v138, v142
    v_max_f32 v139, v139, v143
    v_mul_f32_e64 v129, -v128, v136
    v_mul_f32_e64 v131, -v130, v137
    v_mul_f32_e64 v133, -v132, v138
    v_mul_f32_e64 v135, -v134, v139
    v_pk_fma_f32 v[64:65], v[64:65], v[128:129], v[128:129] op_sel:[0,0,1] op_sel_hi:[1,0,1]
    v_pk_fma_f32 v[68:69], v[68:69], v[130:131], v[130:131] op_sel:[0,0,1] op_sel_hi:[1,0,1]
    v_pk_fma_f32 v[72:73], v[72:73], v[132:133], v[132:133] op_sel:[0,0,1] op_sel_hi:[1,0,1]
    v_pk_fma_f32 v[76:77], v[76:77], v[134:135], v[134:135] op_sel:[0,0,1] op_sel_hi:[1,0,1]
    v_exp_f32 v64, v64
    v_exp_f32 v65, v65
    v_exp_f32 v68, v68
    v_exp_f32 v69, v69
    v_exp_f32 v72, v72
    v_exp_f32 v73, v73
    v_exp_f32 v76, v76
    v_exp_f32 v77, v77
    v_cvt_pk_bf16_f32 v64, v64, v64
    v_cvt_pk_bf16_f32 v65, v65, v65
    v_cvt_pk_bf16_f32 v68, v68, v68
    v_cvt_pk_bf16_f32 v69, v69, v69
    v_cvt_pk_bf16_f32 v72, v72, v72
    v_cvt_pk_bf16_f32 v73, v73, v73
    v_cvt_pk_bf16_f32 v76, v76, v76
    v_cvt_pk_bf16_f32 v77, v77, v77
    v_and_b32 v44, v104, v64
    v_and_b32 v45, v105, v65
    v_and_b32 v46, v106, v64
    v_and_b32 v47, v107, v65
    v_and_b32 v48, v104, v68
    v_and_b32 v49, v105, v69
    v_and_b32 v50, v106, v68
    v_and_b32 v51, v107, v69
    v_mfma_f32_16x16x32_bf16 v[8:11], a[64:67], v[44:47], 0
    v_mfma_f32_16x16x32_bf16 v[24:27], v[154:157], v[44:47], 0
    v_and_b32 v52, v104, v72
    v_and_b32 v53, v105, v73
    v_and_b32 v54, v106, v72
    v_and_b32 v55, v107, v73
    v_mfma_f32_16x16x32_bf16 v[12:15], a[64:67], v[48:51], 0
    v_mfma_f32_16x16x32_bf16 v[28:31], v[156:159], v[48:51], 0
    v_and_b32 v56, v104, v76
    v_and_b32 v57, v105, v77
    v_and_b32 v58, v106, v76
    v_and_b32 v59, v107, v77
    v_mfma_f32_16x16x32_bf16 v[16:19], a[64:67], v[52:55], 0
    v_mfma_f32_16x16x32_bf16 v[32:35], v[158:161], v[52:55], 0
    v_mfma_f32_16x16x32_bf16 v[20:23], a[64:67], v[56:59], 0
    v_mfma_f32_16x16x32_bf16 v[36:39], v[160:163], v[56:59], 0
    v_rcp_f32 v8, v8
    s_nop 0
    v_pk_mul_f32 v[24:25], v[24:25], v[8:9] op_sel_hi:[1,0]
    v_pk_mul_f32 v[26:27], v[26:27], v[8:9] op_sel_hi:[1,0]
    v_cvt_pk_bf16_f32 v80, v24, v25
    v_cvt_pk_bf16_f32 v81, v26, v27
    v_rcp_f32 v12, v12
    s_nop 0
    v_pk_mul_f32 v[28:29], v[28:29], v[12:13] op_sel_hi:[1,0]
    v_pk_mul_f32 v[30:31], v[30:31], v[12:13] op_sel_hi:[1,0]
    v_cvt_pk_bf16_f32 v82, v28, v29
    v_cvt_pk_bf16_f32 v83, v30, v31
    buffer_store_dwordx4 v[80:83], v164, s[56:59], s60 offen sc1
    s_add_u32 s60, s60, 32768
    v_rcp_f32 v16, v16
    s_nop 0
    v_pk_mul_f32 v[32:33], v[32:33], v[16:17] op_sel_hi:[1,0]
    v_pk_mul_f32 v[34:35], v[34:35], v[16:17] op_sel_hi:[1,0]
    v_cvt_pk_bf16_f32 v100, v32, v33
    v_cvt_pk_bf16_f32 v101, v34, v35
    v_rcp_f32 v20, v20
    s_nop 0
    v_pk_mul_f32 v[36:37], v[36:37], v[20:21] op_sel_hi:[1,0]
    v_pk_mul_f32 v[38:39], v[38:39], v[20:21] op_sel_hi:[1,0]
    v_cvt_pk_bf16_f32 v102, v36, v37
    v_cvt_pk_bf16_f32 v103, v38, v39
    buffer_store_dwordx4 v[100:103], v164, s[56:59], s60 offen sc1
    s_add_u32 s48, s34, 0x200000
    s_addc_u32 s49, s35, 0
    s_mov_b32 s50, 0x200000
    s_mov_b32 s51, 0x20000
    s_mov_b32 s52, s34
    s_mov_b32 s53, s35
    s_mov_b32 s54, 0x200000
    s_mov_b32 s55, 0x20000
    v_lshlrev_b32 v116, 4, v0
    s_lshl_b32 s4, s39, 5
    s_add_u32 s4, s4, s38
    s_lshl_b32 s56, s4, 10
    s_lshl_b32 s5, s40, 14
    s_add_u32 s58, s56, s5
    s_lshl_b32 s4, s37, 1
    s_add_u32 s4, s4, s40
    s_lshl_b32 s4, s4, 10
    s_add_u32 s56, s56, s4
    s_add_u32 s57, s56, 16384
    v_lshrrev_b32 v8, 2, v0
    v_bfe_u32 v9, v0, 3, 2
    s_lshl_b32 s4, s40, 1
    v_xor_b32 v9, s4, v9
    v_lshlrev_b32 v8, 7, v8
    v_lshl_add_u32 v8, v9, 5, v8
    v_and_b32 v9, 3, v0
    v_lshl_add_u32 v8, v9, 3, v8
    s_mul_i32 s4, s40, 32768
    s_add_u32 s4, s4, 92160
    v_add_u32 v117, s4, v8
    v_xor_b32 v118, 32, v117
    v_xor_b32 v119, 64, v117
    v_xor_b32 v120, 96, v117
    s_lshl_b32 s4, s3, 12
    s_add_u32 s5, s4, 73728
    v_add_u32 v121, s5, v116
    s_xor_b32 s4, s4, 8192
    s_add_u32 s5, s4, 73728
    v_add_u32 v122, s5, v116
    v_and_b32 v10, 1, v2
    v_lshrrev_b32 v8, 1, v2
    s_lshl_b32 s4, s40, 2
    v_or_b32 v8, s4, v8
    v_lshrrev_b32 v9, 1, v1
    v_xor_b32 v8, v8, v9
    v_lshlrev_b32 v8, 4, v8
    v_lshl_add_u32 v8, v10, 3, v8
    v_lshl_add_u32 v8, v1, 7, v8
    s_lshl_b32 s4, s39, 12
    s_add_u32 s4, s4, 73728
    v_add_u32 v123, s4, v8
    v_xor_b32 v124, 32, v123
    v_lshlrev_b32 v125, 3, v1
    v_lshl_add_u32 v125, v2, 11, v125
    s_lshl_b32 s4, s37, 1
    s_add_u32 s4, s4, s40
    s_lshl_b32 s5, s39, 5
    s_add_u32 s5, s5, s38
    s_add_u32 s4, s4, s5
    s_lshl_b32 s4, s4, 7
    s_add_u32 s61, s4, 0x20000
    v_mov_b32 v126, 0x3f803f80
    s_setprio 3
    s_lshr_b32 s6, s43, 1
    s_lshl_b32 s6, s6, 13
    s_and_b32 s5, s43, 1
    s_lshl_b32 s5, s5, 10
    s_add_u32 s6, s6, s5
    s_add_u32 s6, s6, 0x80800
    s_lshl_b32 s7, s36, 13
    s_and_b32 s5, s14, 15
    s_lshl_b32 s5, s5, 7
    s_add_u32 s7, s7, s5
    s_add_u32 s7, s7, 0x80800
    v_mov_b32 v7, 163584
    s_mov_b64 exec, 1
    s_waitcnt vmcnt(0) lgkmcnt(0)
    ds_add_rtn_u32 v6, v7, v5
    s_mov_b64 exec, 0xff
    v_lshlrev_b32 v7, 7, v0
    s_waitcnt lgkmcnt(0)
    v_readfirstlane_b32 s5, v6
    s_nop 0
    s_cmp_lg_u32 s5, 3
    s_cbranch_scc1 L_47
    buffer_atomic_add v5, v7, s[44:47], s6 offen sc1
L_47:
    s_mov_b64 exec, -1
    s_cmp_lg_u32 s3, 0
    s_cbranch_scc1 L_48
    s_mov_b64 exec, 1
    s_mov_b32 s5, 0
    v_mov_b32 v6, 0
    buffer_atomic_add v6, v4, s[44:47], s7 offen sc0 sc1
    s_sleep 3
    v_mov_b32 v7, 0
    buffer_atomic_add v7, v4, s[44:47], s7 offen sc0 sc1
    s_sleep 3
    v_mov_b32 v175, 0
    buffer_atomic_add v175, v4, s[44:47], s7 offen sc0 sc1
L_50:
    s_waitcnt vmcnt(2)
    v_cmp_le_u32 vcc, 8, v6
    s_cbranch_vccnz L_49
    v_mov_b32 v6, 0
    buffer_atomic_add v6, v4, s[44:47], s7 offen sc0 sc1
    s_waitcnt vmcnt(2)
    v_cmp_le_u32 vcc, 8, v7
    s_cbranch_vccnz L_49
    v_mov_b32 v7, 0
    buffer_atomic_add v7, v4, s[44:47], s7 offen sc0 sc1
    s_waitcnt vmcnt(2)
    v_cmp_le_u32 vcc, 8, v175
    s_cbranch_vccnz L_49
    v_mov_b32 v175, 0
    buffer_atomic_add v175, v4, s[44:47], s7 offen sc0 sc1
    s_add_u32 s5, s5, 1
    s_cmp_lt_u32 s5, 50000
    s_cbranch_scc1 L_50
L_49:
    s_mov_b64 exec, -1
L_48:
    s_barrier
    s_add_u32 s59, s58, 0
    buffer_load_dwordx4 v[52:55], v116, s[52:55], s59 offen sc1
    buffer_load_dwordx4 v[56:59], v116, s[52:55], s59 offen offset:1024 sc1
    buffer_load_dwordx4 v[60:63], v116, s[52:55], s59 offen offset:2048 sc1
    buffer_load_dwordx4 v[64:67], v116, s[52:55], s59 offen offset:3072 sc1
    s_add_u32 s59, s58, 4096
    buffer_load_dwordx4 v[68:71], v116, s[52:55], s59 offen sc1
    buffer_load_dwordx4 v[72:75], v116, s[52:55], s59 offen offset:1024 sc1
    buffer_load_dwordx4 v[76:79], v116, s[52:55], s59 offen offset:2048 sc1
    buffer_load_dwordx4 v[80:83], v116, s[52:55], s59 offen offset:3072 sc1
    ds_read_b64 v[44:45], v123 offset:0
    ds_read_b64 v[46:47], v124 offset:0
    ds_read_b64 v[48:49], v123 offset:2048
    ds_read_b64 v[50:51], v124 offset:2048
    s_waitcnt lgkmcnt(0)
    ds_read_b64_tr_b16 a[0:1], v117 offset:0
    ds_read_b64_tr_b16 a[2:3], v117 offset:2048
    ds_read_b64_tr_b16 a[4:5], v118 offset:0
    ds_read_b64_tr_b16 a[6:7], v118 offset:2048
    ds_read_b64_tr_b16 a[8:9], v119 offset:0
    ds_read_b64_tr_b16 a[10:11], v119 offset:2048
    ds_read_b64_tr_b16 a[12:13], v120 offset:0
    ds_read_b64_tr_b16 a[14:15], v120 offset:2048
    ds_read_b64_tr_b16 a[16:17], v117 offset:4096
    ds_read_b64_tr_b16 a[18:19], v117 offset:6144
    ds_read_b64_tr_b16 a[20:21], v118 offset:4096
    ds_read_b64_tr_b16 a[22:23], v118 offset:6144
    ds_read_b64_tr_b16 a[24:25], v119 offset:4096
    ds_read_b64_tr_b16 a[26:27], v119 offset:6144
    ds_read_b64_tr_b16 a[28:29], v120 offset:4096
    ds_read_b64_tr_b16 a[30:31], v120 offset:6144
    v_lshlrev_b32 v12, 16, v44
    v_and_b32 v13, 0xffff0000, v44
    v_lshlrev_b32 v14, 16, v45
    v_and_b32 v15, 0xffff0000, v45
    v_lshlrev_b32 v16, 16, v46
    v_and_b32 v17, 0xffff0000, v46
    v_lshlrev_b32 v18, 16, v47
    v_and_b32 v19, 0xffff0000, v47
    v_lshlrev_b32 v28, 16, v48
    v_and_b32 v29, 0xffff0000, v48
    v_lshlrev_b32 v30, 16, v49
    v_and_b32 v31, 0xffff0000, v49
    v_lshlrev_b32 v32, 16, v50
    v_and_b32 v33, 0xffff0000, v50
    v_lshlrev_b32 v34, 16, v51
    v_and_b32 v35, 0xffff0000, v51
    s_waitcnt vmcnt(6) lgkmcnt(8)
    v_swap_b32 v54, v56
    v_swap_b32 v55, v57
    s_nop 1
    v_mfma_f32_16x16x32_bf16 v[12:15], a[0:3], v[52:55], v[12:15]
    ds_read_b64_tr_b16 a[32:33], v117 offset:8192
    s_add_u32 s59, s58, 8192
    v_mfma_f32_16x16x32_bf16 v[16:19], a[4:7], v[52:55], v[16:19]
    ds_read_b64_tr_b16 a[34:35], v117 offset:10240
    buffer_load_dwordx4 v[84:87], v116, s[52:55], s59 offen sc1
    v_mfma_f32_16x16x32_bf16 v[20:23], a[8:11], v[52:55], 0
    ds_read_b64_tr_b16 a[36:37], v118 offset:8192
    v_mfma_f32_16x16x32_bf16 v[24:27], a[12:15], v[52:55], 0
    ds_read_b64_tr_b16 a[38:39], v118 offset:10240
    buffer_load_dwordx4 v[88:91], v116, s[52:55], s59 offen offset:1024 sc1
    v_mfma_f32_16x16x32_bf16 v[28:31], a[0:3], v[56:59], v[28:31]
    ds_read_b64_tr_b16 a[40:41], v119 offset:8192
    buffer_load_dwordx4 v[92:95], v116, s[52:55], s59 offen offset:2048 sc1
    v_mfma_f32_16x16x32_bf16 v[32:35], a[4:7], v[56:59], v[32:35]
    ds_read_b64_tr_b16 a[42:43], v119 offset:10240
    v_mfma_f32_16x16x32_bf16 v[36:39], a[8:11], v[56:59], 0
    ds_read_b64_tr_b16 a[44:45], v120 offset:8192
    buffer_load_dwordx4 v[96:99], v116, s[52:55], s59 offen offset:3072 sc1
    v_mfma_f32_16x16x32_bf16 v[40:43], a[12:15], v[56:59], 0
    ds_read_b64_tr_b16 a[46:47], v120 offset:10240
    s_waitcnt vmcnt(8) lgkmcnt(8)
    v_swap_b32 v62, v64
    v_swap_b32 v63, v65
    s_nop 1
    v_mfma_f32_16x16x32_bf16 v[12:15], a[16:19], v[60:63], v[12:15]
    ds_read_b64_tr_b16 a[48:49], v117 offset:12288
    s_add_u32 s59, s58, 12288
    v_mfma_f32_16x16x32_bf16 v[16:19], a[20:23], v[60:63], v[16:19]
    ds_read_b64_tr_b16 a[50:51], v117 offset:14336
    buffer_load_dwordx4 v[100:103], v116, s[52:55], s59 offen sc1
    v_mfma_f32_16x16x32_bf16 v[20:23], a[24:27], v[60:63], v[20:23]
    ds_read_b64_tr_b16 a[52:53], v118 offset:12288
    v_mfma_f32_16x16x32_bf16 v[24:27], a[28:31], v[60:63], v[24:27]
    ds_read_b64_tr_b16 a[54:55], v118 offset:14336
    buffer_load_dwordx4 v[104:107], v116, s[52:55], s59 offen offset:1024 sc1
    v_mfma_f32_16x16x32_bf16 v[28:31], a[16:19], v[64:67], v[28:31]
    ds_read_b64_tr_b16 a[56:57], v119 offset:12288
    buffer_load_dwordx4 v[108:111], v116, s[52:55], s59 offen offset:2048 sc1
    v_mfma_f32_16x16x32_bf16 v[32:35], a[20:23], v[64:67], v[32:35]
    ds_read_b64_tr_b16 a[58:59], v119 offset:14336
    v_mfma_f32_16x16x32_bf16 v[36:39], a[24:27], v[64:67], v[36:39]
    ds_read_b64_tr_b16 a[60:61], v120 offset:12288
    buffer_load_dwordx4 v[112:115], v116, s[52:55], s59 offen offset:3072 sc1
    v_mfma_f32_16x16x32_bf16 v[40:43], a[28:31], v[64:67], v[40:43]
    ds_read_b64_tr_b16 a[62:63], v120 offset:14336
    s_barrier
    s_waitcnt vmcnt(10) lgkmcnt(8)
    v_swap_b32 v70, v72
    v_swap_b32 v71, v73
    s_nop 1
    v_mfma_f32_16x16x32_bf16 v[12:15], a[32:35], v[68:71], v[12:15]
    ds_read_b64_tr_b16 a[0:1], v117 offset:16384
    v_mfma_f32_16x16x32_bf16 v[16:19], a[36:39], v[68:71], v[16:19]
    ds_read_b64_tr_b16 a[2:3], v117 offset:18432
    v_mfma_f32_16x16x32_bf16 v[20:23], a[40:43], v[68:71], v[20:23]
    ds_read_b64_tr_b16 a[4:5], v118 offset:16384
    v_mfma_f32_16x16x32_bf16 v[24:27], a[44:47], v[68:71], v[24:27]
    ds_read_b64_tr_b16 a[6:7], v118 offset:18432
    v_mfma_f32_16x16x32_bf16 v[28:31], a[32:35], v[72:75], v[28:31]
    ds_read_b64_tr_b16 a[8:9], v119 offset:16384
    v_mfma_f32_16x16x32_bf16 v[32:35], a[36:39], v[72:75], v[32:35]
    ds_read_b64_tr_b16 a[10:11], v119 offset:18432
    v_mfma_f32_16x16x32_bf16 v[36:39], a[40:43], v[72:75], v[36:39]
    ds_read_b64_tr_b16 a[12:13], v120 offset:16384
    v_mfma_f32_16x16x32_bf16 v[40:43], a[44:47], v[72:75], v[40:43]
    ds_read_b64_tr_b16 a[14:15], v120 offset:18432
    s_waitcnt vmcnt(8) lgkmcnt(8)
    v_swap_b32 v78, v80
    v_swap_b32 v79, v81
    s_nop 1
    v_mfma_f32_16x16x32_bf16 v[12:15], a[48:51], v[76:79], v[12:15]
    ds_read_b64_tr_b16 a[16:17], v117 offset:20480
    v_mfma_f32_16x16x32_bf16 v[16:19], a[52:55], v[76:79], v[16:19]
    ds_read_b64_tr_b16 a[18:19], v117 offset:22528
    v_mfma_f32_16x16x32_bf16 v[20:23], a[56:59], v[76:79], v[20:23]
    ds_read_b64_tr_b16 a[20:21], v118 offset:20480
    v_mfma_f32_16x16x32_bf16 v[24:27], a[60:63], v[76:79], v[24:27]
    ds_read_b64_tr_b16 a[22:23], v118 offset:22528
    v_mfma_f32_16x16x32_bf16 v[28:31], a[48:51], v[80:83], v[28:31]
    ds_read_b64_tr_b16 a[24:25], v119 offset:20480
    v_mfma_f32_16x16x32_bf16 v[32:35], a[52:55], v[80:83], v[32:35]
    ds_read_b64_tr_b16 a[26:27], v119 offset:22528
    v_mfma_f32_16x16x32_bf16 v[36:39], a[56:59], v[80:83], v[36:39]
    ds_read_b64_tr_b16 a[28:29], v120 offset:20480
    v_mfma_f32_16x16x32_bf16 v[40:43], a[60:63], v[80:83], v[40:43]
    ds_read_b64_tr_b16 a[30:31], v120 offset:22528
    s_waitcnt vmcnt(6) lgkmcnt(8)
    v_swap_b32 v86, v88
    v_swap_b32 v87, v89
    s_nop 1
    v_mfma_f32_16x16x32_bf16 v[12:15], a[0:3], v[84:87], v[12:15]
    ds_read_b64_tr_b16 a[32:33], v117 offset:24576
    v_mfma_f32_16x16x32_bf16 v[16:19], a[4:7], v[84:87], v[16:19]
    ds_read_b64_tr_b16 a[34:35], v117 offset:26624
    v_mfma_f32_16x16x32_bf16 v[20:23], a[8:11], v[84:87], v[20:23]
    ds_read_b64_tr_b16 a[36:37], v118 offset:24576
    v_mfma_f32_16x16x32_bf16 v[24:27], a[12:15], v[84:87], v[24:27]
    ds_read_b64_tr_b16 a[38:39], v118 offset:26624
    v_mfma_f32_16x16x32_bf16 v[28:31], a[0:3], v[88:91], v[28:31]
    ds_read_b64_tr_b16 a[40:41], v119 offset:24576
    v_mfma_f32_16x16x32_bf16 v[32:35], a[4:7], v[88:91], v[32:35]
    ds_read_b64_tr_b16 a[42:43], v119 offset:26624
    v_mfma_f32_16x16x32_bf16 v[36:39], a[8:11], v[88:91], v[36:39]
    ds_read_b64_tr_b16 a[44:45], v120 offset:24576
    v_mfma_f32_16x16x32_bf16 v[40:43], a[12:15], v[88:91], v[40:43]
    ds_read_b64_tr_b16 a[46:47], v120 offset:26624
    s_waitcnt vmcnt(4) lgkmcnt(8)
    v_swap_b32 v94, v96
    v_swap_b32 v95, v97
    s_nop 1
    v_mfma_f32_16x16x32_bf16 v[12:15], a[16:19], v[92:95], v[12:15]
    ds_read_b64_tr_b16 a[48:49], v117 offset:28672
    v_mfma_f32_16x16x32_bf16 v[16:19], a[20:23], v[92:95], v[16:19]
    ds_read_b64_tr_b16 a[50:51], v117 offset:30720
    v_mfma_f32_16x16x32_bf16 v[20:23], a[24:27], v[92:95], v[20:23]
    ds_read_b64_tr_b16 a[52:53], v118 offset:28672
    v_mfma_f32_16x16x32_bf16 v[24:27], a[28:31], v[92:95], v[24:27]
    ds_read_b64_tr_b16 a[54:55], v118 offset:30720
    v_mfma_f32_16x16x32_bf16 v[28:31], a[16:19], v[96:99], v[28:31]
    ds_read_b64_tr_b16 a[56:57], v119 offset:28672
    v_mfma_f32_16x16x32_bf16 v[32:35], a[20:23], v[96:99], v[32:35]
    ds_read_b64_tr_b16 a[58:59], v119 offset:30720
    v_mfma_f32_16x16x32_bf16 v[36:39], a[24:27], v[96:99], v[36:39]
    ds_read_b64_tr_b16 a[60:61], v120 offset:28672
    v_mfma_f32_16x16x32_bf16 v[40:43], a[28:31], v[96:99], v[40:43]
    ds_read_b64_tr_b16 a[62:63], v120 offset:30720
    s_waitcnt vmcnt(2) lgkmcnt(8)
    v_swap_b32 v102, v104
    v_swap_b32 v103, v105
    s_nop 1
    v_mfma_f32_16x16x32_bf16 v[12:15], a[32:35], v[100:103], v[12:15]
    v_mfma_f32_16x16x32_bf16 v[16:19], a[36:39], v[100:103], v[16:19]
    v_mfma_f32_16x16x32_bf16 v[20:23], a[40:43], v[100:103], v[20:23]
    v_mfma_f32_16x16x32_bf16 v[24:27], a[44:47], v[100:103], v[24:27]
    v_mfma_f32_16x16x32_bf16 v[28:31], a[32:35], v[104:107], v[28:31]
    v_mfma_f32_16x16x32_bf16 v[32:35], a[36:39], v[104:107], v[32:35]
    v_mfma_f32_16x16x32_bf16 v[36:39], a[40:43], v[104:107], v[36:39]
    v_mfma_f32_16x16x32_bf16 v[40:43], a[44:47], v[104:107], v[40:43]
    s_waitcnt vmcnt(0) lgkmcnt(0)
    v_swap_b32 v110, v112
    v_swap_b32 v111, v113
    s_nop 1
    v_mfma_f32_16x16x32_bf16 v[12:15], a[48:51], v[108:111], v[12:15]
    v_mfma_f32_16x16x32_bf16 v[16:19], a[52:55], v[108:111], v[16:19]
    v_mfma_f32_16x16x32_bf16 v[20:23], a[56:59], v[108:111], v[20:23]
    v_mfma_f32_16x16x32_bf16 v[24:27], a[60:63], v[108:111], v[24:27]
    v_mfma_f32_16x16x32_bf16 v[28:31], a[48:51], v[112:115], v[28:31]
    v_mfma_f32_16x16x32_bf16 v[32:35], a[52:55], v[112:115], v[32:35]
    v_mfma_f32_16x16x32_bf16 v[36:39], a[56:59], v[112:115], v[36:39]
    v_mfma_f32_16x16x32_bf16 v[40:43], a[60:63], v[112:115], v[40:43]
    s_nop 2
    ds_write_b128 v121, v[20:23] offset:0
    ds_write_b128 v121, v[24:27] offset:1024
    s_nop 1
    ds_write_b128 v121, v[36:39] offset:2048
    ds_write_b128 v121, v[40:43] offset:3072
    s_waitcnt lgkmcnt(0)
    s_barrier
    ds_read_b128 v[20:23], v122 offset:0
    ds_read_b128 v[24:27], v122 offset:1024
    ds_read_b128 v[36:39], v122 offset:2048
    ds_read_b128 v[40:43], v122 offset:3072
    s_waitcnt lgkmcnt(2)
    v_pk_add_f32 v[12:13], v[12:13], v[20:21]
    v_pk_add_f32 v[14:15], v[14:15], v[22:23]
    v_pk_add_f32 v[16:17], v[16:17], v[24:25]
    v_pk_add_f32 v[18:19], v[18:19], v[26:27]
    v_cvt_pk_bf16_f32 v44, v12, v13
    v_cvt_pk_bf16_f32 v45, v14, v15
    v_cvt_pk_bf16_f32 v46, v16, v17
    v_cvt_pk_bf16_f32 v47, v18, v19
    buffer_store_dwordx4 v[44:47], v116, s[48:51], s56 offen sc1
    s_waitcnt lgkmcnt(0)
    v_pk_add_f32 v[28:29], v[28:29], v[36:37]
    v_pk_add_f32 v[30:31], v[30:31], v[38:39]
    v_pk_add_f32 v[32:33], v[32:33], v[40:41]
    v_pk_add_f32 v[34:35], v[34:35], v[42:43]
    v_cvt_pk_bf16_f32 v48, v28, v29
    v_cvt_pk_bf16_f32 v49, v30, v31
    v_cvt_pk_bf16_f32 v50, v32, v33
    v_cvt_pk_bf16_f32 v51, v34, v35
    buffer_store_dwordx4 v[48:51], v116, s[48:51], s57 offen sc1
    s_barrier
    v_dot2_f32_bf16 v128, v44, v126, 0
    v_dot2_f32_bf16 v129, v44, v44, 0
    v_dot2_f32_bf16 v130, v48, v126, 0
    v_dot2_f32_bf16 v131, v48, v48, 0
    v_dot2_f32_bf16 v128, v45, v126, v128
    v_dot2_f32_bf16 v129, v45, v45, v129
    v_dot2_f32_bf16 v130, v49, v126, v130
    v_dot2_f32_bf16 v131, v49, v49, v131
    v_dot2_f32_bf16 v128, v46, v126, v128
    v_dot2_f32_bf16 v129, v46, v46, v129
    v_dot2_f32_bf16 v130, v50, v126, v130
    v_dot2_f32_bf16 v131, v50, v50, v131
    v_dot2_f32_bf16 v128, v47, v126, v128
    v_dot2_f32_bf16 v129, v47, v47, v129
    v_dot2_f32_bf16 v130, v51, v126, v130
    v_dot2_f32_bf16 v131, v51, v51, v131
    s_nop 1
    v_permlane16_swap_b32 v128, v130
    v_permlane16_swap_b32 v129, v131
    v_add_f32 v128, v128, v130
    v_add_f32 v129, v129, v131
    v_mov_b32 v130, v128
    v_mov_b32 v131, v129
    s_nop 0
    v_permlane32_swap_b32 v128, v130
    v_permlane32_swap_b32 v129, v131
    v_add_f32 v128, v128, v130
    v_add_f32 v129, v129, v131
    s_mov_b32 exec_hi, 0
    buffer_store_dwordx2 v[128:129], v125, s[44:47], s61 offen sc1
    s_mov_b64 exec, -1
    s_add_u32 s48, s34, 0x200000
    s_addc_u32 s49, s35, 0
    s_mov_b32 s50, 0x200000
    s_mov_b32 s51, 0x20000
    s_add_u32 s52, s34, 0x400000
    s_addc_u32 s53, s35, 0
    s_mov_b32 s54, 0x580000
    s_mov_b32 s55, 0x20000
    v_lshlrev_b32 v152, 4, v0
    v_add_u32 v153, 16384, v152
    s_lshl_b32 s4, s41, 2
    s_add_u32 s4, s4, s3
    s_lshl_b32 s56, s4, 15
    s_mul_i32 s58, s4, 90112
    s_lshl_b32 s4, s3, 9
    s_add_u32 s4, s4, 157696
    v_lshl_add_u32 v154, v1, 4, s4
    v_add_u32 v155, 45056, v152
    v_add_u32 v156, 90112, v152
    v_add_u32 v157, 135168, v152
    v_lshlrev_b32 v158, 4, v2
    v_add_u32 v158, 159744, v158
    s_lshl_b32 s4, s42, 11
    s_add_u32 s59, s58, s4
    s_add_u32 s60, s59, 32768
    s_lshl_b32 s4, s42, 10
    s_add_u32 s4, s4, 65536
    s_add_u32 s61, s58, s4
    s_lshl_b32 s4, s42, 9
    s_add_u32 s4, s4, 81920
    s_add_u32 s62, s58, s4
    s_setprio 3
    s_lshl_b32 s6, s36, 13
    s_add_u32 s6, s6, 0x81000
    s_lshl_b32 s7, s41, 13
    s_and_b32 s5, s42, 15
    s_lshl_b32 s5, s5, 7
    s_add_u32 s7, s7, s5
    s_add_u32 s7, s7, 0x81000
    v_mov_b32 v7, 163584
    s_mov_b64 exec, 1
    s_waitcnt vmcnt(0) lgkmcnt(0)
    ds_add_rtn_u32 v6, v7, v5
    s_mov_b64 exec, 0xffff
    v_lshlrev_b32 v7, 7, v0
    s_waitcnt lgkmcnt(0)
    v_readfirstlane_b32 s5, v6
    s_nop 0
    s_cmp_lg_u32 s5, 7
    s_cbranch_scc1 L_51
    buffer_atomic_add v5, v7, s[44:47], s6 offen sc1
L_51:
    s_mov_b64 exec, -1
    ds_read_b128 a[0:3], v152 offset:0
    ds_read_b128 a[4:7], v152 offset:1024
    ds_read_b128 a[8:11], v152 offset:2048
    ds_read_b128 a[12:15], v152 offset:3072
    ds_read_b128 a[16:19], v152 offset:4096
    ds_read_b128 a[20:23], v152 offset:5120
    ds_read_b128 a[24:27], v152 offset:6144
    ds_read_b128 a[28:31], v152 offset:7168
    ds_read_b128 a[32:35], v152 offset:8192
    ds_read_b128 a[36:39], v152 offset:9216
    ds_read_b128 a[40:43], v152 offset:10240
    s_cmp_lg_u32 s3, 0
    s_cbranch_scc1 L_52
    s_mov_b64 exec, 1
    s_mov_b32 s5, 0
    v_mov_b32 v6, 0
    buffer_atomic_add v6, v4, s[44:47], s7 offen sc0 sc1
    s_sleep 3
    v_mov_b32 v7, 0
    buffer_atomic_add v7, v4, s[44:47], s7 offen sc0 sc1
    s_sleep 3
    v_mov_b32 v175, 0
    buffer_atomic_add v175, v4, s[44:47], s7 offen sc0 sc1
L_54:
    s_waitcnt vmcnt(2)
    v_cmp_le_u32 vcc, 16, v6
    s_cbranch_vccnz L_53
    v_mov_b32 v6, 0
    buffer_atomic_add v6, v4, s[44:47], s7 offen sc0 sc1
    s_waitcnt vmcnt(2)
    v_cmp_le_u32 vcc, 16, v7
    s_cbranch_vccnz L_53
    v_mov_b32 v7, 0
    buffer_atomic_add v7, v4, s[44:47], s7 offen sc0 sc1
    s_waitcnt vmcnt(2)
    v_cmp_le_u32 vcc, 16, v175
    s_cbranch_vccnz L_53
    v_mov_b32 v175, 0
    buffer_atomic_add v175, v4, s[44:47], s7 offen sc0 sc1
    s_add_u32 s5, s5, 1
    s_cmp_lt_u32 s5, 50000
    s_cbranch_scc1 L_54
L_53:
    s_mov_b64 exec, -1
L_52:
    s_barrier
    s_add_u32 s57, s41, 0
    s_and_b32 s57, s57, 7
    s_lshl_b32 s57, s57, 11
    s_add_u32 s57, s57, s56
    buffer_load_dwordx4 v[104:107], v152, s[48:51], s57 offen sc1
    buffer_load_dwordx4 v[108:111], v153, s[48:51], s57 offen sc1
    buffer_load_dwordx4 v[112:115], v152, s[48:51], s57 offen offset:1024 sc1
    buffer_load_dwordx4 v[116:119], v153, s[48:51], s57 offen offset:1024 sc1
    s_add_u32 s57, s41, 1
    s_and_b32 s57, s57, 7
    s_lshl_b32 s57, s57, 11
    s_add_u32 s57, s57, s56
    buffer_load_dwordx4 a[44:47], v152, s[48:51], s57 offen sc1
    buffer_load_dwordx4 a[48:51], v153, s[48:51], s57 offen sc1
    buffer_load_dwordx4 a[52:55], v152, s[48:51], s57 offen offset:1024 sc1
    buffer_load_dwordx4 a[56:59], v153, s[48:51], s57 offen offset:1024 sc1
    s_waitcnt vmcnt(6) lgkmcnt(7)
    v_mfma_f32_16x16x32_bf16 v[8:11], a[0:3], v[104:107], 0
    v_mfma_f32_16x16x32_bf16 v[12:15], a[0:3], v[108:111], 0
    ds_read_b128 a[0:3], v152 offset:11264
    v_mfma_f32_16x16x32_bf16 v[16:19], a[4:7], v[104:107], 0
    s_add_u32 s57, s41, 2
    s_and_b32 s57, s57, 7
    s_lshl_b32 s57, s57, 11
    s_add_u32 s57, s57, s56
    v_mfma_f32_16x16x32_bf16 v[20:23], a[4:7], v[108:111], 0
    ds_read_b128 a[4:7], v152 offset:12288
    v_mfma_f32_16x16x32_bf16 v[24:27], a[8:11], v[104:107], 0
    v_mfma_f32_16x16x32_bf16 v[28:31], a[8:11], v[108:111], 0
    ds_read_b128 a[8:11], v152 offset:13312
    v_mfma_f32_16x16x32_bf16 v[32:35], a[12:15], v[104:107], 0
    buffer_load_dwordx4 a[60:63], v152, s[48:51], s57 offen sc1
    v_mfma_f32_16x16x32_bf16 v[36:39], a[12:15], v[108:111], 0
    ds_read_b128 a[12:15], v152 offset:14336
    s_waitcnt lgkmcnt(7)
    v_mfma_f32_16x16x32_bf16 v[40:43], a[16:19], v[104:107], 0
    v_mfma_f32_16x16x32_bf16 v[44:47], a[16:19], v[108:111], 0
    ds_read_b128 a[16:19], v152 offset:15360
    v_mfma_f32_16x16x32_bf16 v[48:51], a[20:23], v[104:107], 0
    buffer_load_dwordx4 a[64:67], v153, s[48:51], s57 offen sc1
    v_mfma_f32_16x16x32_bf16 v[52:55], a[20:23], v[108:111], 0
    ds_read_b128 a[20:23], v152 offset:16384
    v_mfma_f32_16x16x32_bf16 v[56:59], a[24:27], v[104:107], 0
    v_mfma_f32_16x16x32_bf16 v[60:63], a[24:27], v[108:111], 0
    ds_read_b128 a[24:27], v152 offset:17408
    v_mfma_f32_16x16x32_bf16 v[64:67], a[28:31], v[104:107], 0
    buffer_load_dwordx4 a[68:71], v152, s[48:51], s57 offen offset:1024 sc1
    v_mfma_f32_16x16x32_bf16 v[68:71], a[28:31], v[108:111], 0
    ds_read_b128 a[28:31], v152 offset:18432
    s_waitcnt lgkmcnt(8)
    v_mfma_f32_16x16x32_bf16 v[72:75], a[32:35], v[104:107], 0
    v_mfma_f32_16x16x32_bf16 v[76:79], a[32:35], v[108:111], 0
    ds_read_b128 a[32:35], v152 offset:19456
    v_mfma_f32_16x16x32_bf16 v[80:83], a[36:39], v[104:107], 0
    buffer_load_dwordx4 a[72:75], v153, s[48:51], s57 offen offset:1024 sc1
    v_mfma_f32_16x16x32_bf16 v[84:87], a[36:39], v[108:111], 0
    ds_read_b128 a[36:39], v152 offset:20480
    v_mfma_f32_16x16x32_bf16 v[88:91], a[40:43], v[104:107], 0
    v_mfma_f32_16x16x32_bf16 v[92:95], a[40:43], v[108:111], 0
    ds_read_b128 a[40:43], v152 offset:21504
    s_waitcnt vmcnt(8) lgkmcnt(7)
    v_mfma_f32_16x16x32_bf16 v[8:11], a[0:3], v[112:115], v[8:11]
    v_mfma_f32_16x16x32_bf16 v[12:15], a[0:3], v[116:119], v[12:15]
    ds_read_b128 a[0:3], v152 offset:22528
    v_mfma_f32_16x16x32_bf16 v[16:19], a[4:7], v[112:115], v[16:19]
    s_add_u32 s57, s41, 3
    s_and_b32 s57, s57, 7
    s_lshl_b32 s57, s57, 11
    s_add_u32 s57, s57, s56
    v_mfma_f32_16x16x32_bf16 v[20:23], a[4:7], v[116:119], v[20:23]
    ds_read_b128 a[4:7], v152 offset:23552
    v_mfma_f32_16x16x32_bf16 v[24:27], a[8:11], v[112:115], v[24:27]
    v_mfma_f32_16x16x32_bf16 v[28:31], a[8:11], v[116:119], v[28:31]
    ds_read_b128 a[8:11], v152 offset:24576
    v_mfma_f32_16x16x32_bf16 v[32:35], a[12:15], v[112:115], v[32:35]
    buffer_load_dwordx4 v[120:123], v152, s[48:51], s57 offen sc1
    v_mfma_f32_16x16x32_bf16 v[36:39], a[12:15], v[116:119], v[36:39]
    ds_read_b128 a[12:15], v152 offset:25600
    s_waitcnt lgkmcnt(7)
    v_mfma_f32_16x16x32_bf16 v[40:43], a[16:19], v[112:115], v[40:43]
    v_mfma_f32_16x16x32_bf16 v[44:47], a[16:19], v[116:119], v[44:47]
    ds_read_b128 a[16:19], v152 offset:26624
    v_mfma_f32_16x16x32_bf16 v[48:51], a[20:23], v[112:115], v[48:51]
    buffer_load_dwordx4 v[124:127], v153, s[48:51], s57 offen sc1
    v_mfma_f32_16x16x32_bf16 v[52:55], a[20:23], v[116:119], v[52:55]
    ds_read_b128 a[20:23], v152 offset:27648
    v_mfma_f32_16x16x32_bf16 v[56:59], a[24:27], v[112:115], v[56:59]
    v_mfma_f32_16x16x32_bf16 v[60:63], a[24:27], v[116:119], v[60:63]
    ds_read_b128 a[24:27], v152 offset:28672
    v_mfma_f32_16x16x32_bf16 v[64:67], a[28:31], v[112:115], v[64:67]
    buffer_load_dwordx4 v[128:131], v152, s[48:51], s57 offen offset:1024 sc1
    v_mfma_f32_16x16x32_bf16 v[68:71], a[28:31], v[116:119], v[68:71]
    ds_read_b128 a[28:31], v152 offset:29696
    s_waitcnt lgkmcnt(8)
    v_mfma_f32_16x16x32_bf16 v[72:75], a[32:35], v[112:115], v[72:75]
    v_mfma_f32_16x16x32_bf16 v[76:79], a[32:35], v[116:119], v[76:79]
    ds_read_b128 a[32:35], v152 offset:30720
    v_mfma_f32_16x16x32_bf16 v[80:83], a[36:39], v[112:115], v[80:83]
    buffer_load_dwordx4 v[132:135], v153, s[48:51], s57 offen offset:1024 sc1
    v_mfma_f32_16x16x32_bf16 v[84:87], a[36:39], v[116:119], v[84:87]
    ds_read_b128 a[36:39], v152 offset:31744
    v_mfma_f32_16x16x32_bf16 v[88:91], a[40:43], v[112:115], v[88:91]
    v_mfma_f32_16x16x32_bf16 v[92:95], a[40:43], v[116:119], v[92:95]
    ds_read_b128 a[40:43], v152 offset:32768
    s_waitcnt vmcnt(10) lgkmcnt(7)
    v_mfma_f32_16x16x32_bf16 v[8:11], a[0:3], a[44:47], v[8:11]
    v_mfma_f32_16x16x32_bf16 v[12:15], a[0:3], a[48:51], v[12:15]
    ds_read_b128 a[0:3], v152 offset:33792
    v_mfma_f32_16x16x32_bf16 v[16:19], a[4:7], a[44:47], v[16:19]
    s_add_u32 s57, s41, 4
    s_and_b32 s57, s57, 7
    s_lshl_b32 s57, s57, 11
    s_add_u32 s57, s57, s56
    v_mfma_f32_16x16x32_bf16 v[20:23], a[4:7], a[48:51], v[20:23]
    ds_read_b128 a[4:7], v152 offset:34816
    v_mfma_f32_16x16x32_bf16 v[24:27], a[8:11], a[44:47], v[24:27]
    v_mfma_f32_16x16x32_bf16 v[28:31], a[8:11], a[48:51], v[28:31]
    ds_read_b128 a[8:11], v152 offset:35840
    v_mfma_f32_16x16x32_bf16 v[32:35], a[12:15], a[44:47], v[32:35]
    buffer_load_dwordx4 v[136:139], v152, s[48:51], s57 offen sc1
    v_mfma_f32_16x16x32_bf16 v[36:39], a[12:15], a[48:51], v[36:39]
    ds_read_b128 a[12:15], v152 offset:36864
    s_waitcnt lgkmcnt(7)
    v_mfma_f32_16x16x32_bf16 v[40:43], a[16:19], a[44:47], v[40:43]
    v_mfma_f32_16x16x32_bf16 v[44:47], a[16:19], a[48:51], v[44:47]
    ds_read_b128 a[16:19], v152 offset:37888
    v_mfma_f32_16x16x32_bf16 v[48:51], a[20:23], a[44:47], v[48:51]
    buffer_load_dwordx4 v[140:143], v153, s[48:51], s57 offen sc1
    v_mfma_f32_16x16x32_bf16 v[52:55], a[20:23], a[48:51], v[52:55]
    ds_read_b128 a[20:23], v152 offset:38912
    v_mfma_f32_16x16x32_bf16 v[56:59], a[24:27], a[44:47], v[56:59]
    v_mfma_f32_16x16x32_bf16 v[60:63], a[24:27], a[48:51], v[60:63]
    ds_read_b128 a[24:27], v152 offset:39936
    v_mfma_f32_16x16x32_bf16 v[64:67], a[28:31], a[44:47], v[64:67]
    buffer_load_dwordx4 v[144:147], v152, s[48:51], s57 offen offset:1024 sc1
    v_mfma_f32_16x16x32_bf16 v[68:71], a[28:31], a[48:51], v[68:71]
    ds_read_b128 a[28:31], v152 offset:40960
    s_waitcnt lgkmcnt(8)
    v_mfma_f32_16x16x32_bf16 v[72:75], a[32:35], a[44:47], v[72:75]
    v_mfma_f32_16x16x32_bf16 v[76:79], a[32:35], a[48:51], v[76:79]
    ds_read_b128 a[32:35], v152 offset:41984
    v_mfma_f32_16x16x32_bf16 v[80:83], a[36:39], a[44:47], v[80:83]
    buffer_load_dwordx4 v[148:151], v153, s[48:51], s57 offen offset:1024 sc1
    v_mfma_f32_16x16x32_bf16 v[84:87], a[36:39], a[48:51], v[84:87]
    ds_read_b128 a[36:39], v152 offset:43008
    v_mfma_f32_16x16x32_bf16 v[88:91], a[40:43], a[44:47], v[88:91]
    v_mfma_f32_16x16x32_bf16 v[92:95], a[40:43], a[48:51], v[92:95]
    ds_read_b128 a[40:43], v152 offset:44032
    s_barrier
    s_waitcnt vmcnt(12) lgkmcnt(7)
    v_mfma_f32_16x16x32_bf16 v[8:11], a[0:3], a[52:55], v[8:11]
    v_mfma_f32_16x16x32_bf16 v[12:15], a[0:3], a[56:59], v[12:15]
    ds_read_b128 a[0:3], v155 offset:0
    v_mfma_f32_16x16x32_bf16 v[16:19], a[4:7], a[52:55], v[16:19]
    s_add_u32 s57, s41, 5
    s_and_b32 s57, s57, 7
    s_lshl_b32 s57, s57, 11
    s_add_u32 s57, s57, s56
    v_mfma_f32_16x16x32_bf16 v[20:23], a[4:7], a[56:59], v[20:23]
    ds_read_b128 a[4:7], v155 offset:1024
    v_mfma_f32_16x16x32_bf16 v[24:27], a[8:11], a[52:55], v[24:27]
    v_mfma_f32_16x16x32_bf16 v[28:31], a[8:11], a[56:59], v[28:31]
    ds_read_b128 a[8:11], v155 offset:2048
    v_mfma_f32_16x16x32_bf16 v[32:35], a[12:15], a[52:55], v[32:35]
    buffer_load_dwordx4 v[104:107], v152, s[48:51], s57 offen sc1
    v_mfma_f32_16x16x32_bf16 v[36:39], a[12:15], a[56:59], v[36:39]
    ds_read_b128 a[12:15], v155 offset:3072
    s_waitcnt lgkmcnt(7)
    v_mfma_f32_16x16x32_bf16 v[40:43], a[16:19], a[52:55], v[40:43]
    v_mfma_f32_16x16x32_bf16 v[44:47], a[16:19], a[56:59], v[44:47]
    ds_read_b128 a[16:19], v155 offset:4096
    v_mfma_f32_16x16x32_bf16 v[48:51], a[20:23], a[52:55], v[48:51]
    buffer_load_dwordx4 v[108:111], v153, s[48:51], s57 offen sc1
    v_mfma_f32_16x16x32_bf16 v[52:55], a[20:23], a[56:59], v[52:55]
    ds_read_b128 a[20:23], v155 offset:5120
    v_mfma_f32_16x16x32_bf16 v[56:59], a[24:27], a[52:55], v[56:59]
    v_mfma_f32_16x16x32_bf16 v[60:63], a[24:27], a[56:59], v[60:63]
    ds_read_b128 a[24:27], v155 offset:6144
    v_mfma_f32_16x16x32_bf16 v[64:67], a[28:31], a[52:55], v[64:67]
    buffer_load_dwordx4 v[112:115], v152, s[48:51], s57 offen offset:1024 sc1
    v_mfma_f32_16x16x32_bf16 v[68:71], a[28:31], a[56:59], v[68:71]
    ds_read_b128 a[28:31], v155 offset:7168
    s_waitcnt lgkmcnt(8)
    v_mfma_f32_16x16x32_bf16 v[72:75], a[32:35], a[52:55], v[72:75]
    v_mfma_f32_16x16x32_bf16 v[76:79], a[32:35], a[56:59], v[76:79]
    ds_read_b128 a[32:35], v155 offset:8192
    v_mfma_f32_16x16x32_bf16 v[80:83], a[36:39], a[52:55], v[80:83]
    buffer_load_dwordx4 v[116:119], v153, s[48:51], s57 offen offset:1024 sc1
    v_mfma_f32_16x16x32_bf16 v[84:87], a[36:39], a[56:59], v[84:87]
    ds_read_b128 a[36:39], v155 offset:9216
    v_mfma_f32_16x16x32_bf16 v[88:91], a[40:43], a[52:55], v[88:91]
    v_mfma_f32_16x16x32_bf16 v[92:95], a[40:43], a[56:59], v[92:95]
    ds_read_b128 a[40:43], v155 offset:10240
    s_waitcnt vmcnt(14) lgkmcnt(7)
    v_mfma_f32_16x16x32_bf16 v[8:11], a[0:3], a[60:63], v[8:11]
    v_mfma_f32_16x16x32_bf16 v[12:15], a[0:3], a[64:67], v[12:15]
    ds_read_b128 a[0:3], v155 offset:11264
    v_mfma_f32_16x16x32_bf16 v[16:19], a[4:7], a[60:63], v[16:19]
    s_add_u32 s57, s41, 6
    s_and_b32 s57, s57, 7
    s_lshl_b32 s57, s57, 11
    s_add_u32 s57, s57, s56
    v_mfma_f32_16x16x32_bf16 v[20:23], a[4:7], a[64:67], v[20:23]
    ds_read_b128 a[4:7], v155 offset:12288
    v_mfma_f32_16x16x32_bf16 v[24:27], a[8:11], a[60:63], v[24:27]
    v_mfma_f32_16x16x32_bf16 v[28:31], a[8:11], a[64:67], v[28:31]
    ds_read_b128 a[8:11], v155 offset:13312
    v_mfma_f32_16x16x32_bf16 v[32:35], a[12:15], a[60:63], v[32:35]
    buffer_load_dwordx4 a[44:47], v152, s[48:51], s57 offen sc1
    v_mfma_f32_16x16x32_bf16 v[36:39], a[12:15], a[64:67], v[36:39]
    ds_read_b128 a[12:15], v155 offset:14336
    s_waitcnt lgkmcnt(7)
    v_mfma_f32_16x16x32_bf16 v[40:43], a[16:19], a[60:63], v[40:43]
    v_mfma_f32_16x16x32_bf16 v[44:47], a[16:19], a[64:67], v[44:47]
    ds_read_b128 a[16:19], v155 offset:15360
    v_mfma_f32_16x16x32_bf16 v[48:51], a[20:23], a[60:63], v[48:51]
    buffer_load_dwordx4 a[48:51], v153, s[48:51], s57 offen sc1
    v_mfma_f32_16x16x32_bf16 v[52:55], a[20:23], a[64:67], v[52:55]
    ds_read_b128 a[20:23], v155 offset:16384
    v_mfma_f32_16x16x32_bf16 v[56:59], a[24:27], a[60:63], v[56:59]
    v_mfma_f32_16x16x32_bf16 v[60:63], a[24:27], a[64:67], v[60:63]
    ds_read_b128 a[24:27], v155 offset:17408
    v_mfma_f32_16x16x32_bf16 v[64:67], a[28:31], a[60:63], v[64:67]
    buffer_load_dwordx4 a[52:55], v152, s[48:51], s57 offen offset:1024 sc1
    v_mfma_f32_16x16x32_bf16 v[68:71], a[28:31], a[64:67], v[68:71]
    ds_read_b128 a[28:31], v155 offset:18432
    s_waitcnt lgkmcnt(8)
    v_mfma_f32_16x16x32_bf16 v[72:75], a[32:35], a[60:63], v[72:75]
    v_mfma_f32_16x16x32_bf16 v[76:79], a[32:35], a[64:67], v[76:79]
    ds_read_b128 a[32:35], v155 offset:19456
    v_mfma_f32_16x16x32_bf16 v[80:83], a[36:39], a[60:63], v[80:83]
    buffer_load_dwordx4 a[56:59], v153, s[48:51], s57 offen offset:1024 sc1
    v_mfma_f32_16x16x32_bf16 v[84:87], a[36:39], a[64:67], v[84:87]
    ds_read_b128 a[36:39], v155 offset:20480
    v_mfma_f32_16x16x32_bf16 v[88:91], a[40:43], a[60:63], v[88:91]
    v_mfma_f32_16x16x32_bf16 v[92:95], a[40:43], a[64:67], v[92:95]
    ds_read_b128 a[40:43], v155 offset:21504
    s_waitcnt vmcnt(16) lgkmcnt(7)
    v_mfma_f32_16x16x32_bf16 v[8:11], a[0:3], a[68:71], v[8:11]
    v_mfma_f32_16x16x32_bf16 v[12:15], a[0:3], a[72:75], v[12:15]
    ds_read_b128 a[0:3], v155 offset:22528
    v_mfma_f32_16x16x32_bf16 v[16:19], a[4:7], a[68:71], v[16:19]
    s_add_u32 s57, s41, 7
    s_and_b32 s57, s57, 7
    s_lshl_b32 s57, s57, 11
    s_add_u32 s57, s57, s56
    v_mfma_f32_16x16x32_bf16 v[20:23], a[4:7], a[72:75], v[20:23]
    ds_read_b128 a[4:7], v155 offset:23552
    v_mfma_f32_16x16x32_bf16 v[24:27], a[8:11], a[68:71], v[24:27]
    v_mfma_f32_16x16x32_bf16 v[28:31], a[8:11], a[72:75], v[28:31]
    ds_read_b128 a[8:11], v155 offset:24576
    v_mfma_f32_16x16x32_bf16 v[32:35], a[12:15], a[68:71], v[32:35]
    buffer_load_dwordx4 a[60:63], v152, s[48:51], s57 offen sc1
    v_mfma_f32_16x16x32_bf16 v[36:39], a[12:15], a[72:75], v[36:39]
    ds_read_b128 a[12:15], v155 offset:25600
    s_waitcnt lgkmcnt(7)
    v_mfma_f32_16x16x32_bf16 v[40:43], a[16:19], a[68:71], v[40:43]
    v_mfma_f32_16x16x32_bf16 v[44:47], a[16:19], a[72:75], v[44:47]
    ds_read_b128 a[16:19], v155 offset:26624
    v_mfma_f32_16x16x32_bf16 v[48:51], a[20:23], a[68:71], v[48:51]
    buffer_load_dwordx4 a[64:67], v153, s[48:51], s57 offen sc1
    v_mfma_f32_16x16x32_bf16 v[52:55], a[20:23], a[72:75], v[52:55]
    ds_read_b128 a[20:23], v155 offset:27648
    v_mfma_f32_16x16x32_bf16 v[56:59], a[24:27], a[68:71], v[56:59]
    v_mfma_f32_16x16x32_bf16 v[60:63], a[24:27], a[72:75], v[60:63]
    ds_read_b128 a[24:27], v155 offset:28672
    v_mfma_f32_16x16x32_bf16 v[64:67], a[28:31], a[68:71], v[64:67]
    v_mfma_f32_16x16x32_bf16 v[68:71], a[28:31], a[72:75], v[68:71]
    ds_read_b128 a[28:31], v155 offset:29696
    s_waitcnt lgkmcnt(8)
    v_mfma_f32_16x16x32_bf16 v[72:75], a[32:35], a[68:71], v[72:75]
    v_mfma_f32_16x16x32_bf16 v[76:79], a[32:35], a[72:75], v[76:79]
    ds_read_b128 a[32:35], v155 offset:30720
    v_mfma_f32_16x16x32_bf16 v[80:83], a[36:39], a[68:71], v[80:83]
    v_mfma_f32_16x16x32_bf16 v[84:87], a[36:39], a[72:75], v[84:87]
    ds_read_b128 a[36:39], v155 offset:31744
    v_mfma_f32_16x16x32_bf16 v[88:91], a[40:43], a[68:71], v[88:91]
    v_mfma_f32_16x16x32_bf16 v[92:95], a[40:43], a[72:75], v[92:95]
    ds_read_b128 a[40:43], v155 offset:32768
    s_waitcnt vmcnt(16) lgkmcnt(7)
    v_mfma_f32_16x16x32_bf16 v[8:11], a[0:3], v[120:123], v[8:11]
    v_mfma_f32_16x16x32_bf16 v[12:15], a[0:3], v[124:127], v[12:15]
    ds_read_b128 a[0:3], v155 offset:33792
    v_mfma_f32_16x16x32_bf16 v[16:19], a[4:7], v[120:123], v[16:19]
    buffer_load_dwordx4 a[68:71], v152, s[48:51], s57 offen offset:1024 sc1
    v_mfma_f32_16x16x32_bf16 v[20:23], a[4:7], v[124:127], v[20:23]
    ds_read_b128 a[4:7], v155 offset:34816
    v_mfma_f32_16x16x32_bf16 v[24:27], a[8:11], v[120:123], v[24:27]
    v_mfma_f32_16x16x32_bf16 v[28:31], a[8:11], v[124:127], v[28:31]
    ds_read_b128 a[8:11], v155 offset:35840
    v_mfma_f32_16x16x32_bf16 v[32:35], a[12:15], v[120:123], v[32:35]
    buffer_load_dwordx4 a[72:75], v153, s[48:51], s57 offen offset:1024 sc1
    v_mfma_f32_16x16x32_bf16 v[36:39], a[12:15], v[124:127], v[36:39]
    ds_read_b128 a[12:15], v155 offset:36864
    s_waitcnt lgkmcnt(7)
    v_mfma_f32_16x16x32_bf16 v[40:43], a[16:19], v[120:123], v[40:43]
    v_mfma_f32_16x16x32_bf16 v[44:47], a[16:19], v[124:127], v[44:47]
    ds_read_b128 a[16:19], v155 offset:37888
    v_mfma_f32_16x16x32_bf16 v[48:51], a[20:23], v[120:123], v[48:51]
    v_mfma_f32_16x16x32_bf16 v[52:55], a[20:23], v[124:127], v[52:55]
    ds_read_b128 a[20:23], v155 offset:38912
    v_mfma_f32_16x16x32_bf16 v[56:59], a[24:27], v[120:123], v[56:59]
    v_mfma_f32_16x16x32_bf16 v[60:63], a[24:27], v[124:127], v[60:63]
    ds_read_b128 a[24:27], v155 offset:39936
    v_mfma_f32_16x16x32_bf16 v[64:67], a[28:31], v[120:123], v[64:67]
    v_mfma_f32_16x16x32_bf16 v[68:71], a[28:31], v[124:127], v[68:71]
    ds_read_b128 a[28:31], v155 offset:40960
    s_waitcnt lgkmcnt(8)
    v_mfma_f32_16x16x32_bf16 v[72:75], a[32:35], v[120:123], v[72:75]
    v_mfma_f32_16x16x32_bf16 v[76:79], a[32:35], v[124:127], v[76:79]
    ds_read_b128 a[32:35], v155 offset:41984
    v_mfma_f32_16x16x32_bf16 v[80:83], a[36:39], v[120:123], v[80:83]
    v_mfma_f32_16x16x32_bf16 v[84:87], a[36:39], v[124:127], v[84:87]
    ds_read_b128 a[36:39], v155 offset:43008
    v_mfma_f32_16x16x32_bf16 v[88:91], a[40:43], v[120:123], v[88:91]
    v_mfma_f32_16x16x32_bf16 v[92:95], a[40:43], v[124:127], v[92:95]
    ds_read_b128 a[40:43], v155 offset:44032
    s_barrier
    s_waitcnt vmcnt(16) lgkmcnt(7)
    v_mfma_f32_16x16x32_bf16 v[8:11], a[0:3], v[128:131], v[8:11]
    v_mfma_f32_16x16x32_bf16 v[12:15], a[0:3], v[132:135], v[12:15]
    ds_read_b128 a[0:3], v156 offset:0
    v_mfma_f32_16x16x32_bf16 v[16:19], a[4:7], v[128:131], v[16:19]
    v_mfma_f32_16x16x32_bf16 v[20:23], a[4:7], v[132:135], v[20:23]
    ds_read_b128 a[4:7], v156 offset:1024
    v_mfma_f32_16x16x32_bf16 v[24:27], a[8:11], v[128:131], v[24:27]
    v_mfma_f32_16x16x32_bf16 v[28:31], a[8:11], v[132:135], v[28:31]
    ds_read_b128 a[8:11], v156 offset:2048
    v_mfma_f32_16x16x32_bf16 v[32:35], a[12:15], v[128:131], v[32:35]
    v_mfma_f32_16x16x32_bf16 v[36:39], a[12:15], v[132:135], v[36:39]
    ds_read_b128 a[12:15], v156 offset:3072
    s_waitcnt lgkmcnt(7)
    v_mfma_f32_16x16x32_bf16 v[40:43], a[16:19], v[128:131], v[40:43]
    v_mfma_f32_16x16x32_bf16 v[44:47], a[16:19], v[132:135], v[44:47]
    ds_read_b128 a[16:19], v156 offset:4096
    v_mfma_f32_16x16x32_bf16 v[48:51], a[20:23], v[128:131], v[48:51]
    v_mfma_f32_16x16x32_bf16 v[52:55], a[20:23], v[132:135], v[52:55]
    ds_read_b128 a[20:23], v156 offset:5120
    v_mfma_f32_16x16x32_bf16 v[56:59], a[24:27], v[128:131], v[56:59]
    v_mfma_f32_16x16x32_bf16 v[60:63], a[24:27], v[132:135], v[60:63]
    ds_read_b128 a[24:27], v156 offset:6144
    v_mfma_f32_16x16x32_bf16 v[64:67], a[28:31], v[128:131], v[64:67]
    v_mfma_f32_16x16x32_bf16 v[68:71], a[28:31], v[132:135], v[68:71]
    ds_read_b128 a[28:31], v156 offset:7168
    s_waitcnt lgkmcnt(8)
    v_mfma_f32_16x16x32_bf16 v[72:75], a[32:35], v[128:131], v[72:75]
    v_mfma_f32_16x16x32_bf16 v[76:79], a[32:35], v[132:135], v[76:79]
    ds_read_b128 a[32:35], v156 offset:8192
    v_mfma_f32_16x16x32_bf16 v[80:83], a[36:39], v[128:131], v[80:83]
    v_mfma_f32_16x16x32_bf16 v[84:87], a[36:39], v[132:135], v[84:87]
    ds_read_b128 a[36:39], v156 offset:9216
    v_mfma_f32_16x16x32_bf16 v[88:91], a[40:43], v[128:131], v[88:91]
    v_mfma_f32_16x16x32_bf16 v[92:95], a[40:43], v[132:135], v[92:95]
    ds_read_b128 a[40:43], v156 offset:10240
    s_waitcnt vmcnt(14) lgkmcnt(7)
    v_mfma_f32_16x16x32_bf16 v[8:11], a[0:3], v[136:139], v[8:11]
    v_mfma_f32_16x16x32_bf16 v[12:15], a[0:3], v[140:143], v[12:15]
    ds_read_b128 a[0:3], v156 offset:11264
    v_mfma_f32_16x16x32_bf16 v[16:19], a[4:7], v[136:139], v[16:19]
    v_mfma_f32_16x16x32_bf16 v[20:23], a[4:7], v[140:143], v[20:23]
    ds_read_b128 a[4:7], v156 offset:12288
    v_mfma_f32_16x16x32_bf16 v[24:27], a[8:11], v[136:139], v[24:27]
    v_mfma_f32_16x16x32_bf16 v[28:31], a[8:11], v[140:143], v[28:31]
    ds_read_b128 a[8:11], v156 offset:13312
    v_mfma_f32_16x16x32_bf16 v[32:35], a[12:15], v[136:139], v[32:35]
    v_mfma_f32_16x16x32_bf16 v[36:39], a[12:15], v[140:143], v[36:39]
    ds_read_b128 a[12:15], v156 offset:14336
    s_waitcnt lgkmcnt(7)
    v_mfma_f32_16x16x32_bf16 v[40:43], a[16:19], v[136:139], v[40:43]
    v_mfma_f32_16x16x32_bf16 v[44:47], a[16:19], v[140:143], v[44:47]
    ds_read_b128 a[16:19], v156 offset:15360
    v_mfma_f32_16x16x32_bf16 v[48:51], a[20:23], v[136:139], v[48:51]
    v_mfma_f32_16x16x32_bf16 v[52:55], a[20:23], v[140:143], v[52:55]
    ds_read_b128 a[20:23], v156 offset:16384
    v_mfma_f32_16x16x32_bf16 v[56:59], a[24:27], v[136:139], v[56:59]
    v_mfma_f32_16x16x32_bf16 v[60:63], a[24:27], v[140:143], v[60:63]
    ds_read_b128 a[24:27], v156 offset:17408
    v_mfma_f32_16x16x32_bf16 v[64:67], a[28:31], v[136:139], v[64:67]
    v_mfma_f32_16x16x32_bf16 v[68:71], a[28:31], v[140:143], v[68:71]
    ds_read_b128 a[28:31], v156 offset:18432
    s_waitcnt lgkmcnt(8)
    v_mfma_f32_16x16x32_bf16 v[72:75], a[32:35], v[136:139], v[72:75]
    v_mfma_f32_16x16x32_bf16 v[76:79], a[32:35], v[140:143], v[76:79]
    ds_read_b128 a[32:35], v156 offset:19456
    v_mfma_f32_16x16x32_bf16 v[80:83], a[36:39], v[136:139], v[80:83]
    v_mfma_f32_16x16x32_bf16 v[84:87], a[36:39], v[140:143], v[84:87]
    ds_read_b128 a[36:39], v156 offset:20480
    v_mfma_f32_16x16x32_bf16 v[88:91], a[40:43], v[136:139], v[88:91]
    v_mfma_f32_16x16x32_bf16 v[92:95], a[40:43], v[140:143], v[92:95]
    ds_read_b128 a[40:43], v156 offset:21504
    s_waitcnt vmcnt(12) lgkmcnt(7)
    v_mfma_f32_16x16x32_bf16 v[8:11], a[0:3], v[144:147], v[8:11]
    v_mfma_f32_16x16x32_bf16 v[12:15], a[0:3], v[148:151], v[12:15]
    ds_read_b128 a[0:3], v156 offset:22528
    v_mfma_f32_16x16x32_bf16 v[16:19], a[4:7], v[144:147], v[16:19]
    v_mfma_f32_16x16x32_bf16 v[20:23], a[4:7], v[148:151], v[20:23]
    ds_read_b128 a[4:7], v156 offset:23552
    v_mfma_f32_16x16x32_bf16 v[24:27], a[8:11], v[144:147], v[24:27]
    v_mfma_f32_16x16x32_bf16 v[28:31], a[8:11], v[148:151], v[28:31]
    ds_read_b128 a[8:11], v156 offset:24576
    v_mfma_f32_16x16x32_bf16 v[32:35], a[12:15], v[144:147], v[32:35]
    v_mfma_f32_16x16x32_bf16 v[36:39], a[12:15], v[148:151], v[36:39]
    ds_read_b128 a[12:15], v156 offset:25600
    s_waitcnt lgkmcnt(7)
    v_mfma_f32_16x16x32_bf16 v[40:43], a[16:19], v[144:147], v[40:43]
    v_mfma_f32_16x16x32_bf16 v[44:47], a[16:19], v[148:151], v[44:47]
    ds_read_b128 a[16:19], v156 offset:26624
    v_mfma_f32_16x16x32_bf16 v[48:51], a[20:23], v[144:147], v[48:51]
    v_mfma_f32_16x16x32_bf16 v[52:55], a[20:23], v[148:151], v[52:55]
    ds_read_b128 a[20:23], v156 offset:27648
    v_mfma_f32_16x16x32_bf16 v[56:59], a[24:27], v[144:147], v[56:59]
    v_mfma_f32_16x16x32_bf16 v[60:63], a[24:27], v[148:151], v[60:63]
    ds_read_b128 a[24:27], v156 offset:28672
    v_mfma_f32_16x16x32_bf16 v[64:67], a[28:31], v[144:147], v[64:67]
    v_mfma_f32_16x16x32_bf16 v[68:71], a[28:31], v[148:151], v[68:71]
    ds_read_b128 a[28:31], v156 offset:29696
    s_waitcnt lgkmcnt(8)
    v_mfma_f32_16x16x32_bf16 v[72:75], a[32:35], v[144:147], v[72:75]
    v_mfma_f32_16x16x32_bf16 v[76:79], a[32:35], v[148:151], v[76:79]
    ds_read_b128 a[32:35], v156 offset:30720
    v_mfma_f32_16x16x32_bf16 v[80:83], a[36:39], v[144:147], v[80:83]
    v_mfma_f32_16x16x32_bf16 v[84:87], a[36:39], v[148:151], v[84:87]
    ds_read_b128 a[36:39], v156 offset:31744
    v_mfma_f32_16x16x32_bf16 v[88:91], a[40:43], v[144:147], v[88:91]
    v_mfma_f32_16x16x32_bf16 v[92:95], a[40:43], v[148:151], v[92:95]
    ds_read_b128 a[40:43], v156 offset:32768
    s_waitcnt vmcnt(10) lgkmcnt(7)
    v_mfma_f32_16x16x32_bf16 v[8:11], a[0:3], v[104:107], v[8:11]
    v_mfma_f32_16x16x32_bf16 v[12:15], a[0:3], v[108:111], v[12:15]
    ds_read_b128 a[0:3], v156 offset:33792
    v_mfma_f32_16x16x32_bf16 v[16:19], a[4:7], v[104:107], v[16:19]
    v_mfma_f32_16x16x32_bf16 v[20:23], a[4:7], v[108:111], v[20:23]
    ds_read_b128 a[4:7], v156 offset:34816
    v_mfma_f32_16x16x32_bf16 v[24:27], a[8:11], v[104:107], v[24:27]
    v_mfma_f32_16x16x32_bf16 v[28:31], a[8:11], v[108:111], v[28:31]
    ds_read_b128 a[8:11], v156 offset:35840
    v_mfma_f32_16x16x32_bf16 v[32:35], a[12:15], v[104:107], v[32:35]
    v_mfma_f32_16x16x32_bf16 v[36:39], a[12:15], v[108:111], v[36:39]
    ds_read_b128 a[12:15], v156 offset:36864
    s_waitcnt lgkmcnt(7)
    v_mfma_f32_16x16x32_bf16 v[40:43], a[16:19], v[104:107], v[40:43]
    v_mfma_f32_16x16x32_bf16 v[44:47], a[16:19], v[108:111], v[44:47]
    ds_read_b128 a[16:19], v156 offset:37888
    v_mfma_f32_16x16x32_bf16 v[48:51], a[20:23], v[104:107], v[48:51]
    v_mfma_f32_16x16x32_bf16 v[52:55], a[20:23], v[108:111], v[52:55]
    ds_read_b128 a[20:23], v156 offset:38912
    v_mfma_f32_16x16x32_bf16 v[56:59], a[24:27], v[104:107], v[56:59]
    v_mfma_f32_16x16x32_bf16 v[60:63], a[24:27], v[108:111], v[60:63]
    ds_read_b128 a[24:27], v156 offset:39936
    v_mfma_f32_16x16x32_bf16 v[64:67], a[28:31], v[104:107], v[64:67]
    v_mfma_f32_16x16x32_bf16 v[68:71], a[28:31], v[108:111], v[68:71]
    ds_read_b128 a[28:31], v156 offset:40960
    s_waitcnt lgkmcnt(8)
    v_mfma_f32_16x16x32_bf16 v[72:75], a[32:35], v[104:107], v[72:75]
    v_mfma_f32_16x16x32_bf16 v[76:79], a[32:35], v[108:111], v[76:79]
    ds_read_b128 a[32:35], v156 offset:41984
    v_mfma_f32_16x16x32_bf16 v[80:83], a[36:39], v[104:107], v[80:83]
    v_mfma_f32_16x16x32_bf16 v[84:87], a[36:39], v[108:111], v[84:87]
    ds_read_b128 a[36:39], v156 offset:43008
    v_mfma_f32_16x16x32_bf16 v[88:91], a[40:43], v[104:107], v[88:91]
    v_mfma_f32_16x16x32_bf16 v[92:95], a[40:43], v[108:111], v[92:95]
    ds_read_b128 a[40:43], v156 offset:44032
    s_barrier
    s_waitcnt vmcnt(8) lgkmcnt(7)
    v_mfma_f32_16x16x32_bf16 v[8:11], a[0:3], v[112:115], v[8:11]
    v_mfma_f32_16x16x32_bf16 v[12:15], a[0:3], v[116:119], v[12:15]
    ds_read_b128 a[0:3], v157 offset:0
    v_mfma_f32_16x16x32_bf16 v[16:19], a[4:7], v[112:115], v[16:19]
    v_mfma_f32_16x16x32_bf16 v[20:23], a[4:7], v[116:119], v[20:23]
    ds_read_b128 a[4:7], v157 offset:1024
    v_mfma_f32_16x16x32_bf16 v[24:27], a[8:11], v[112:115], v[24:27]
    v_mfma_f32_16x16x32_bf16 v[28:31], a[8:11], v[116:119], v[28:31]
    ds_read_b128 a[8:11], v157 offset:2048
    v_mfma_f32_16x16x32_bf16 v[32:35], a[12:15], v[112:115], v[32:35]
    v_mfma_f32_16x16x32_bf16 v[36:39], a[12:15], v[116:119], v[36:39]
    ds_read_b128 a[12:15], v157 offset:3072
    s_waitcnt lgkmcnt(7)
    v_mfma_f32_16x16x32_bf16 v[40:43], a[16:19], v[112:115], v[40:43]
    v_mfma_f32_16x16x32_bf16 v[44:47], a[16:19], v[116:119], v[44:47]
    ds_read_b128 a[16:19], v157 offset:4096
    v_mfma_f32_16x16x32_bf16 v[48:51], a[20:23], v[112:115], v[48:51]
    v_mfma_f32_16x16x32_bf16 v[52:55], a[20:23], v[116:119], v[52:55]
    ds_read_b128 a[20:23], v157 offset:5120
    v_mfma_f32_16x16x32_bf16 v[56:59], a[24:27], v[112:115], v[56:59]
    v_mfma_f32_16x16x32_bf16 v[60:63], a[24:27], v[116:119], v[60:63]
    ds_read_b128 a[24:27], v157 offset:6144
    v_mfma_f32_16x16x32_bf16 v[64:67], a[28:31], v[112:115], v[64:67]
    v_mfma_f32_16x16x32_bf16 v[68:71], a[28:31], v[116:119], v[68:71]
    ds_read_b128 a[28:31], v157 offset:7168
    s_waitcnt lgkmcnt(8)
    v_mfma_f32_16x16x32_bf16 v[72:75], a[32:35], v[112:115], v[72:75]
    v_mfma_f32_16x16x32_bf16 v[76:79], a[32:35], v[116:119], v[76:79]
    ds_read_b128 a[32:35], v157 offset:8192
    v_mfma_f32_16x16x32_bf16 v[80:83], a[36:39], v[112:115], v[80:83]
    v_mfma_f32_16x16x32_bf16 v[84:87], a[36:39], v[116:119], v[84:87]
    ds_read_b128 a[36:39], v157 offset:9216
    v_mfma_f32_16x16x32_bf16 v[88:91], a[40:43], v[112:115], v[88:91]
    v_mfma_f32_16x16x32_bf16 v[92:95], a[40:43], v[116:119], v[92:95]
    ds_read_b128 a[40:43], v157 offset:10240
    s_waitcnt vmcnt(6) lgkmcnt(7)
    v_mfma_f32_16x16x32_bf16 v[8:11], a[0:3], a[44:47], v[8:11]
    v_mfma_f32_16x16x32_bf16 v[12:15], a[0:3], a[48:51], v[12:15]
    ds_read_b128 a[0:3], v157 offset:11264
    v_mfma_f32_16x16x32_bf16 v[16:19], a[4:7], a[44:47], v[16:19]
    v_mfma_f32_16x16x32_bf16 v[20:23], a[4:7], a[48:51], v[20:23]
    ds_read_b128 a[4:7], v157 offset:12288
    v_mfma_f32_16x16x32_bf16 v[24:27], a[8:11], a[44:47], v[24:27]
    v_mfma_f32_16x16x32_bf16 v[28:31], a[8:11], a[48:51], v[28:31]
    ds_read_b128 a[8:11], v157 offset:13312
    v_mfma_f32_16x16x32_bf16 v[32:35], a[12:15], a[44:47], v[32:35]
    v_mfma_f32_16x16x32_bf16 v[36:39], a[12:15], a[48:51], v[36:39]
    ds_read_b128 a[12:15], v157 offset:14336
    s_waitcnt lgkmcnt(7)
    v_mfma_f32_16x16x32_bf16 v[40:43], a[16:19], a[44:47], v[40:43]
    v_mfma_f32_16x16x32_bf16 v[44:47], a[16:19], a[48:51], v[44:47]
    ds_read_b128 a[16:19], v157 offset:15360
    v_mfma_f32_16x16x32_bf16 v[48:51], a[20:23], a[44:47], v[48:51]
    v_mfma_f32_16x16x32_bf16 v[52:55], a[20:23], a[48:51], v[52:55]
    ds_read_b128 a[20:23], v157 offset:16384
    v_mfma_f32_16x16x32_bf16 v[56:59], a[24:27], a[44:47], v[56:59]
    v_mfma_f32_16x16x32_bf16 v[60:63], a[24:27], a[48:51], v[60:63]
    ds_read_b128 a[24:27], v157 offset:17408
    v_mfma_f32_16x16x32_bf16 v[64:67], a[28:31], a[44:47], v[64:67]
    v_mfma_f32_16x16x32_bf16 v[68:71], a[28:31], a[48:51], v[68:71]
    ds_read_b128 a[28:31], v157 offset:18432
    s_waitcnt lgkmcnt(8)
    v_mfma_f32_16x16x32_bf16 v[72:75], a[32:35], a[44:47], v[72:75]
    v_mfma_f32_16x16x32_bf16 v[76:79], a[32:35], a[48:51], v[76:79]
    ds_read_b128 a[32:35], v157 offset:19456
    v_mfma_f32_16x16x32_bf16 v[80:83], a[36:39], a[44:47], v[80:83]
    v_mfma_f32_16x16x32_bf16 v[84:87], a[36:39], a[48:51], v[84:87]
    ds_read_b128 a[36:39], v157 offset:20480
    v_mfma_f32_16x16x32_bf16 v[88:91], a[40:43], a[44:47], v[88:91]
    v_mfma_f32_16x16x32_bf16 v[92:95], a[40:43], a[48:51], v[92:95]
    ds_read_b128 a[40:43], v157 offset:21504
    s_waitcnt vmcnt(4) lgkmcnt(7)
    v_mfma_f32_16x16x32_bf16 v[8:11], a[0:3], a[52:55], v[8:11]
    v_mfma_f32_16x16x32_bf16 v[12:15], a[0:3], a[56:59], v[12:15]
    ds_read_b128 a[0:3], v152 offset:0
    v_mfma_f32_16x16x32_bf16 v[16:19], a[4:7], a[52:55], v[16:19]
    v_mfma_f32_16x16x32_bf16 v[20:23], a[4:7], a[56:59], v[20:23]
    ds_read_b128 a[4:7], v152 offset:1024
    v_mfma_f32_16x16x32_bf16 v[24:27], a[8:11], a[52:55], v[24:27]
    v_mfma_f32_16x16x32_bf16 v[28:31], a[8:11], a[56:59], v[28:31]
    ds_read_b128 a[8:11], v152 offset:2048
    v_mfma_f32_16x16x32_bf16 v[32:35], a[12:15], a[52:55], v[32:35]
    v_mfma_f32_16x16x32_bf16 v[36:39], a[12:15], a[56:59], v[36:39]
    ds_read_b128 a[12:15], v152 offset:3072
    s_waitcnt lgkmcnt(7)
    v_mfma_f32_16x16x32_bf16 v[40:43], a[16:19], a[52:55], v[40:43]
    v_mfma_f32_16x16x32_bf16 v[44:47], a[16:19], a[56:59], v[44:47]
    ds_read_b128 a[16:19], v152 offset:4096
    v_mfma_f32_16x16x32_bf16 v[48:51], a[20:23], a[52:55], v[48:51]
    v_mfma_f32_16x16x32_bf16 v[52:55], a[20:23], a[56:59], v[52:55]
    ds_read_b128 a[20:23], v152 offset:5120
    v_mfma_f32_16x16x32_bf16 v[56:59], a[24:27], a[52:55], v[56:59]
    v_mfma_f32_16x16x32_bf16 v[60:63], a[24:27], a[56:59], v[60:63]
    ds_read_b128 a[24:27], v152 offset:6144
    v_mfma_f32_16x16x32_bf16 v[64:67], a[28:31], a[52:55], v[64:67]
    v_mfma_f32_16x16x32_bf16 v[68:71], a[28:31], a[56:59], v[68:71]
    ds_read_b128 a[28:31], v152 offset:7168
    s_waitcnt lgkmcnt(8)
    v_mfma_f32_16x16x32_bf16 v[72:75], a[32:35], a[52:55], v[72:75]
    v_mfma_f32_16x16x32_bf16 v[76:79], a[32:35], a[56:59], v[76:79]
    ds_read_b128 a[32:35], v152 offset:8192
    v_mfma_f32_16x16x32_bf16 v[80:83], a[36:39], a[52:55], v[80:83]
    v_mfma_f32_16x16x32_bf16 v[84:87], a[36:39], a[56:59], v[84:87]
    ds_read_b128 a[36:39], v152 offset:9216
    v_mfma_f32_16x16x32_bf16 v[88:91], a[40:43], a[52:55], v[88:91]
    v_mfma_f32_16x16x32_bf16 v[92:95], a[40:43], a[56:59], v[92:95]
    ds_read_b128 a[40:43], v152 offset:10240
    s_waitcnt vmcnt(2) lgkmcnt(7)
    v_mfma_f32_16x16x32_bf16 v[8:11], a[0:3], a[60:63], v[8:11]
    v_mfma_f32_16x16x32_bf16 v[12:15], a[0:3], a[64:67], v[12:15]
    ds_read_b128 a[0:3], v152 offset:11264
    v_mfma_f32_16x16x32_bf16 v[16:19], a[4:7], a[60:63], v[16:19]
    v_mfma_f32_16x16x32_bf16 v[20:23], a[4:7], a[64:67], v[20:23]
    ds_read_b128 a[4:7], v152 offset:12288
    v_mfma_f32_16x16x32_bf16 v[24:27], a[8:11], a[60:63], v[24:27]
    v_mfma_f32_16x16x32_bf16 v[28:31], a[8:11], a[64:67], v[28:31]
    ds_read_b128 a[8:11], v152 offset:13312
    v_mfma_f32_16x16x32_bf16 v[32:35], a[12:15], a[60:63], v[32:35]
    v_mfma_f32_16x16x32_bf16 v[36:39], a[12:15], a[64:67], v[36:39]
    ds_read_b128 a[12:15], v152 offset:14336
    s_waitcnt lgkmcnt(7)
    v_mfma_f32_16x16x32_bf16 v[40:43], a[16:19], a[60:63], v[40:43]
    v_mfma_f32_16x16x32_bf16 v[44:47], a[16:19], a[64:67], v[44:47]
    ds_read_b128 a[16:19], v152 offset:15360
    v_mfma_f32_16x16x32_bf16 v[48:51], a[20:23], a[60:63], v[48:51]
    v_mfma_f32_16x16x32_bf16 v[52:55], a[20:23], a[64:67], v[52:55]
    ds_read_b128 a[20:23], v152 offset:16384
    v_mfma_f32_16x16x32_bf16 v[56:59], a[24:27], a[60:63], v[56:59]
    v_mfma_f32_16x16x32_bf16 v[60:63], a[24:27], a[64:67], v[60:63]
    ds_read_b128 a[24:27], v152 offset:17408
    v_mfma_f32_16x16x32_bf16 v[64:67], a[28:31], a[60:63], v[64:67]
    v_mfma_f32_16x16x32_bf16 v[68:71], a[28:31], a[64:67], v[68:71]
    ds_read_b128 a[28:31], v152 offset:18432
    s_waitcnt lgkmcnt(8)
    v_mfma_f32_16x16x32_bf16 v[72:75], a[32:35], a[60:63], v[72:75]
    v_mfma_f32_16x16x32_bf16 v[76:79], a[32:35], a[64:67], v[76:79]
    ds_read_b128 a[32:35], v152 offset:19456
    v_mfma_f32_16x16x32_bf16 v[80:83], a[36:39], a[60:63], v[80:83]
    v_mfma_f32_16x16x32_bf16 v[84:87], a[36:39], a[64:67], v[84:87]
    ds_read_b128 a[36:39], v152 offset:20480
    v_mfma_f32_16x16x32_bf16 v[88:91], a[40:43], a[60:63], v[88:91]
    v_mfma_f32_16x16x32_bf16 v[92:95], a[40:43], a[64:67], v[92:95]
    ds_read_b128 a[40:43], v152 offset:21504
    s_waitcnt lgkmcnt(0)
    s_barrier
    s_waitcnt vmcnt(0) lgkmcnt(7)
    v_mfma_f32_16x16x32_bf16 v[8:11], a[0:3], a[68:71], v[8:11]
    v_mfma_f32_16x16x32_bf16 v[12:15], a[0:3], a[72:75], v[12:15]
    ds_read_b128 v[96:99], v154 offset:0
    ds_read_b128 v[100:103], v154 offset:256
    v_mfma_f32_16x16x32_bf16 v[16:19], a[4:7], a[68:71], v[16:19]
    v_mfma_f32_16x16x32_bf16 v[20:23], a[4:7], a[72:75], v[20:23]
    ds_read_b128 v[104:107], v158 offset:0
    ds_read_b128 v[108:111], v158 offset:64
    v_mfma_f32_16x16x32_bf16 v[24:27], a[8:11], a[68:71], v[24:27]
    v_mfma_f32_16x16x32_bf16 v[28:31], a[8:11], a[72:75], v[28:31]
    ds_read_b128 v[112:115], v158 offset:128
    ds_read_b128 v[116:119], v158 offset:192
    v_mfma_f32_16x16x32_bf16 v[32:35], a[12:15], a[68:71], v[32:35]
    v_mfma_f32_16x16x32_bf16 v[36:39], a[12:15], a[72:75], v[36:39]
    ds_read_b128 v[120:123], v158 offset:256
    ds_read_b128 v[124:127], v158 offset:320
    v_mfma_f32_16x16x32_bf16 v[40:43], a[16:19], a[68:71], v[40:43]
    v_mfma_f32_16x16x32_bf16 v[44:47], a[16:19], a[72:75], v[44:47]
    ds_read_b128 v[128:131], v158 offset:384
    ds_read_b128 v[132:135], v158 offset:448
    v_mfma_f32_16x16x32_bf16 v[48:51], a[20:23], a[68:71], v[48:51]
    v_mfma_f32_16x16x32_bf16 v[52:55], a[20:23], a[72:75], v[52:55]
    ds_read_b128 v[136:139], v158 offset:512
    ds_read_b128 v[140:143], v158 offset:576
    v_mfma_f32_16x16x32_bf16 v[56:59], a[24:27], a[68:71], v[56:59]
    v_mfma_f32_16x16x32_bf16 v[60:63], a[24:27], a[72:75], v[60:63]
    ds_read_b128 v[144:147], v158 offset:640
    v_mfma_f32_16x16x32_bf16 v[64:67], a[28:31], a[68:71], v[64:67]
    v_mfma_f32_16x16x32_bf16 v[68:71], a[28:31], a[72:75], v[68:71]
    v_mfma_f32_16x16x32_bf16 v[72:75], a[32:35], a[68:71], v[72:75]
    v_mfma_f32_16x16x32_bf16 v[76:79], a[32:35], a[72:75], v[76:79]
    v_mfma_f32_16x16x32_bf16 v[80:83], a[36:39], a[68:71], v[80:83]
    v_mfma_f32_16x16x32_bf16 v[84:87], a[36:39], a[72:75], v[84:87]
    v_mfma_f32_16x16x32_bf16 v[88:91], a[40:43], a[68:71], v[88:91]
    v_mfma_f32_16x16x32_bf16 v[92:95], a[40:43], a[72:75], v[92:95]
    s_waitcnt lgkmcnt(0)
    v_pk_fma_f32 v[8:9], v[104:105], v[96:97], v[8:9] op_sel:[0,1,0] op_sel_hi:[1,1,1]
    v_pk_fma_f32 v[10:11], v[106:107], v[96:97], v[10:11] op_sel:[0,1,0] op_sel_hi:[1,1,1]
    v_pk_fma_f32 v[12:13], v[104:105], v[100:101], v[12:13] op_sel:[0,1,0] op_sel_hi:[1,1,1]
    v_pk_fma_f32 v[14:15], v[106:107], v[100:101], v[14:15] op_sel:[0,1,0] op_sel_hi:[1,1,1]
    v_pk_fma_f32 v[16:17], v[108:109], v[96:97], v[16:17] op_sel:[0,1,0] op_sel_hi:[1,1,1]
    v_pk_fma_f32 v[18:19], v[110:111], v[96:97], v[18:19] op_sel:[0,1,0] op_sel_hi:[1,1,1]
    v_pk_fma_f32 v[20:21], v[108:109], v[100:101], v[20:21] op_sel:[0,1,0] op_sel_hi:[1,1,1]
    v_pk_fma_f32 v[22:23], v[110:111], v[100:101], v[22:23] op_sel:[0,1,0] op_sel_hi:[1,1,1]
    v_pk_fma_f32 v[24:25], v[112:113], v[96:97], v[24:25] op_sel:[0,1,0] op_sel_hi:[1,1,1]
    v_pk_fma_f32 v[26:27], v[114:115], v[96:97], v[26:27] op_sel:[0,1,0] op_sel_hi:[1,1,1]
    v_pk_fma_f32 v[28:29], v[112:113], v[100:101], v[28:29] op_sel:[0,1,0] op_sel_hi:[1,1,1]
    v_pk_fma_f32 v[30:31], v[114:115], v[100:101], v[30:31] op_sel:[0,1,0] op_sel_hi:[1,1,1]
    v_pk_fma_f32 v[32:33], v[116:117], v[96:97], v[32:33] op_sel:[0,1,0] op_sel_hi:[1,1,1]
    v_pk_fma_f32 v[34:35], v[118:119], v[96:97], v[34:35] op_sel:[0,1,0] op_sel_hi:[1,1,1]
    v_pk_fma_f32 v[36:37], v[116:117], v[100:101], v[36:37] op_sel:[0,1,0] op_sel_hi:[1,1,1]
    v_pk_fma_f32 v[38:39], v[118:119], v[100:101], v[38:39] op_sel:[0,1,0] op_sel_hi:[1,1,1]
    v_pk_mul_f32 v[148:149], v[8:9], v[8:9]
    v_pk_mul_f32 v[150:151], v[10:11], v[10:11]
    v_pk_mul_f32 v[160:161], v[24:25], v[24:25]
    v_pk_mul_f32 v[162:163], v[26:27], v[26:27]
    v_pk_fma_f32 v[148:149], v[148:149], v[98:99], v[98:99] op_sel:[0,1,0] op_sel_hi:[1,1,0]
    v_pk_fma_f32 v[150:151], v[150:151], v[98:99], v[98:99] op_sel:[0,1,0] op_sel_hi:[1,1,0]
    v_pk_fma_f32 v[160:161], v[160:161], v[98:99], v[98:99] op_sel:[0,1,0] op_sel_hi:[1,1,0]
    v_pk_fma_f32 v[162:163], v[162:163], v[98:99], v[98:99] op_sel:[0,1,0] op_sel_hi:[1,1,0]
    v_pk_mul_f32 v[148:149], v[148:149], v[8:9]
    v_pk_mul_f32 v[150:151], v[150:151], v[10:11]
    v_pk_mul_f32 v[160:161], v[160:161], v[24:25]
    v_pk_mul_f32 v[162:163], v[162:163], v[26:27]
    v_exp_f32 v148, v148
    v_exp_f32 v149, v149
    v_exp_f32 v150, v150
    v_exp_f32 v151, v151
    v_exp_f32 v160, v160
    v_exp_f32 v161, v161
    v_exp_f32 v162, v162
    v_exp_f32 v163, v163
    v_pk_mul_f32 v[8:9], v[8:9], v[16:17]
    v_pk_mul_f32 v[10:11], v[10:11], v[18:19]
    v_pk_mul_f32 v[24:25], v[24:25], v[32:33]
    v_pk_mul_f32 v[26:27], v[26:27], v[34:35]
    v_pk_fma_f32 v[148:149], v[148:149], v[96:97], v[96:97] op_sel_hi:[1,0,0]
    v_pk_fma_f32 v[150:151], v[150:151], v[96:97], v[96:97] op_sel_hi:[1,0,0]
    v_pk_fma_f32 v[160:161], v[160:161], v[96:97], v[96:97] op_sel_hi:[1,0,0]
    v_pk_fma_f32 v[162:163], v[162:163], v[96:97], v[96:97] op_sel_hi:[1,0,0]
    v_rcp_f32 v148, v148
    v_rcp_f32 v149, v149
    v_rcp_f32 v150, v150
    v_rcp_f32 v151, v151
    v_rcp_f32 v160, v160
    v_rcp_f32 v161, v161
    v_rcp_f32 v162, v162
    v_rcp_f32 v163, v163
    v_pk_mul_f32 v[8:9], v[8:9], v[148:149]
    v_pk_mul_f32 v[10:11], v[10:11], v[150:151]
    v_pk_mul_f32 v[24:25], v[24:25], v[160:161]
    v_pk_mul_f32 v[26:27], v[26:27], v[162:163]
    v_cvt_pk_bf16_f32 v16, v8, v9
    v_cvt_pk_bf16_f32 v17, v10, v11
    v_cvt_pk_bf16_f32 v18, v24, v25
    v_cvt_pk_bf16_f32 v19, v26, v27
    buffer_store_dwordx4 v[16:19], v152, s[52:55], s59 offen offset:0 sc1
    v_pk_mul_f32 v[148:149], v[12:13], v[12:13]
    v_pk_mul_f32 v[150:151], v[14:15], v[14:15]
    v_pk_mul_f32 v[160:161], v[28:29], v[28:29]
    v_pk_mul_f32 v[162:163], v[30:31], v[30:31]
    v_pk_fma_f32 v[148:149], v[148:149], v[102:103], v[102:103] op_sel:[0,1,0] op_sel_hi:[1,1,0]
    v_pk_fma_f32 v[150:151], v[150:151], v[102:103], v[102:103] op_sel:[0,1,0] op_sel_hi:[1,1,0]
    v_pk_fma_f32 v[160:161], v[160:161], v[102:103], v[102:103] op_sel:[0,1,0] op_sel_hi:[1,1,0]
    v_pk_fma_f32 v[162:163], v[162:163], v[102:103], v[102:103] op_sel:[0,1,0] op_sel_hi:[1,1,0]
    v_pk_mul_f32 v[148:149], v[148:149], v[12:13]
    v_pk_mul_f32 v[150:151], v[150:151], v[14:15]
    v_pk_mul_f32 v[160:161], v[160:161], v[28:29]
    v_pk_mul_f32 v[162:163], v[162:163], v[30:31]
    v_exp_f32 v148, v148
    v_exp_f32 v149, v149
    v_exp_f32 v150, v150
    v_exp_f32 v151, v151
    v_exp_f32 v160, v160
    v_exp_f32 v161, v161
    v_exp_f32 v162, v162
    v_exp_f32 v163, v163
    v_pk_mul_f32 v[12:13], v[12:13], v[20:21]
    v_pk_mul_f32 v[14:15], v[14:15], v[22:23]
    v_pk_mul_f32 v[28:29], v[28:29], v[36:37]
    v_pk_mul_f32 v[30:31], v[30:31], v[38:39]
    v_pk_fma_f32 v[148:149], v[148:149], v[100:101], v[100:101] op_sel_hi:[1,0,0]
    v_pk_fma_f32 v[150:151], v[150:151], v[100:101], v[100:101] op_sel_hi:[1,0,0]
    v_pk_fma_f32 v[160:161], v[160:161], v[100:101], v[100:101] op_sel_hi:[1,0,0]
    v_pk_fma_f32 v[162:163], v[162:163], v[100:101], v[100:101] op_sel_hi:[1,0,0]
    v_rcp_f32 v148, v148
    v_rcp_f32 v149, v149
    v_rcp_f32 v150, v150
    v_rcp_f32 v151, v151
    v_rcp_f32 v160, v160
    v_rcp_f32 v161, v161
    v_rcp_f32 v162, v162
    v_rcp_f32 v163, v163
    v_pk_mul_f32 v[12:13], v[12:13], v[148:149]
    v_pk_mul_f32 v[14:15], v[14:15], v[150:151]
    v_pk_mul_f32 v[28:29], v[28:29], v[160:161]
    v_pk_mul_f32 v[30:31], v[30:31], v[162:163]
    v_cvt_pk_bf16_f32 v20, v12, v13
    v_cvt_pk_bf16_f32 v21, v14, v15
    v_cvt_pk_bf16_f32 v22, v28, v29
    v_cvt_pk_bf16_f32 v23, v30, v31
    buffer_store_dwordx4 v[20:23], v152, s[52:55], s59 offen offset:1024 sc1
    v_pk_fma_f32 v[40:41], v[120:121], v[96:97], v[40:41] op_sel:[0,1,0] op_sel_hi:[1,1,1]
    v_pk_fma_f32 v[42:43], v[122:123], v[96:97], v[42:43] op_sel:[0,1,0] op_sel_hi:[1,1,1]
    v_pk_fma_f32 v[44:45], v[120:121], v[100:101], v[44:45] op_sel:[0,1,0] op_sel_hi:[1,1,1]
    v_pk_fma_f32 v[46:47], v[122:123], v[100:101], v[46:47] op_sel:[0,1,0] op_sel_hi:[1,1,1]
    v_pk_fma_f32 v[48:49], v[124:125], v[96:97], v[48:49] op_sel:[0,1,0] op_sel_hi:[1,1,1]
    v_pk_fma_f32 v[50:51], v[126:127], v[96:97], v[50:51] op_sel:[0,1,0] op_sel_hi:[1,1,1]
    v_pk_fma_f32 v[52:53], v[124:125], v[100:101], v[52:53] op_sel:[0,1,0] op_sel_hi:[1,1,1]
    v_pk_fma_f32 v[54:55], v[126:127], v[100:101], v[54:55] op_sel:[0,1,0] op_sel_hi:[1,1,1]
    v_pk_fma_f32 v[56:57], v[128:129], v[96:97], v[56:57] op_sel:[0,1,0] op_sel_hi:[1,1,1]
    v_pk_fma_f32 v[58:59], v[130:131], v[96:97], v[58:59] op_sel:[0,1,0] op_sel_hi:[1,1,1]
    v_pk_fma_f32 v[60:61], v[128:129], v[100:101], v[60:61] op_sel:[0,1,0] op_sel_hi:[1,1,1]
    v_pk_fma_f32 v[62:63], v[130:131], v[100:101], v[62:63] op_sel:[0,1,0] op_sel_hi:[1,1,1]
    v_pk_fma_f32 v[64:65], v[132:133], v[96:97], v[64:65] op_sel:[0,1,0] op_sel_hi:[1,1,1]
    v_pk_fma_f32 v[66:67], v[134:135], v[96:97], v[66:67] op_sel:[0,1,0] op_sel_hi:[1,1,1]
    v_pk_fma_f32 v[68:69], v[132:133], v[100:101], v[68:69] op_sel:[0,1,0] op_sel_hi:[1,1,1]
    v_pk_fma_f32 v[70:71], v[134:135], v[100:101], v[70:71] op_sel:[0,1,0] op_sel_hi:[1,1,1]
    v_pk_mul_f32 v[148:149], v[40:41], v[40:41]
    v_pk_mul_f32 v[150:151], v[42:43], v[42:43]
    v_pk_mul_f32 v[160:161], v[56:57], v[56:57]
    v_pk_mul_f32 v[162:163], v[58:59], v[58:59]
    v_pk_fma_f32 v[148:149], v[148:149], v[98:99], v[98:99] op_sel:[0,1,0] op_sel_hi:[1,1,0]
    v_pk_fma_f32 v[150:151], v[150:151], v[98:99], v[98:99] op_sel:[0,1,0] op_sel_hi:[1,1,0]
    v_pk_fma_f32 v[160:161], v[160:161], v[98:99], v[98:99] op_sel:[0,1,0] op_sel_hi:[1,1,0]
    v_pk_fma_f32 v[162:163], v[162:163], v[98:99], v[98:99] op_sel:[0,1,0] op_sel_hi:[1,1,0]
    v_pk_mul_f32 v[148:149], v[148:149], v[40:41]
    v_pk_mul_f32 v[150:151], v[150:151], v[42:43]
    v_pk_mul_f32 v[160:161], v[160:161], v[56:57]
    v_pk_mul_f32 v[162:163], v[162:163], v[58:59]
    v_exp_f32 v148, v148
    v_exp_f32 v149, v149
    v_exp_f32 v150, v150
    v_exp_f32 v151, v151
    v_exp_f32 v160, v160
    v_exp_f32 v161, v161
    v_exp_f32 v162, v162
    v_exp_f32 v163, v163
    v_pk_mul_f32 v[40:41], v[40:41], v[48:49]
    v_pk_mul_f32 v[42:43], v[42:43], v[50:51]
    v_pk_mul_f32 v[56:57], v[56:57], v[64:65]
    v_pk_mul_f32 v[58:59], v[58:59], v[66:67]
    v_pk_fma_f32 v[148:149], v[148:149], v[96:97], v[96:97] op_sel_hi:[1,0,0]
    v_pk_fma_f32 v[150:151], v[150:151], v[96:97], v[96:97] op_sel_hi:[1,0,0]
    v_pk_fma_f32 v[160:161], v[160:161], v[96:97], v[96:97] op_sel_hi:[1,0,0]
    v_pk_fma_f32 v[162:163], v[162:163], v[96:97], v[96:97] op_sel_hi:[1,0,0]
    v_rcp_f32 v148, v148
    v_rcp_f32 v149, v149
    v_rcp_f32 v150, v150
    v_rcp_f32 v151, v151
    v_rcp_f32 v160, v160
    v_rcp_f32 v161, v161
    v_rcp_f32 v162, v162
    v_rcp_f32 v163, v163
    v_pk_mul_f32 v[40:41], v[40:41], v[148:149]
    v_pk_mul_f32 v[42:43], v[42:43], v[150:151]
    v_pk_mul_f32 v[56:57], v[56:57], v[160:161]
    v_pk_mul_f32 v[58:59], v[58:59], v[162:163]
    v_cvt_pk_bf16_f32 v48, v40, v41
    v_cvt_pk_bf16_f32 v49, v42, v43
    v_cvt_pk_bf16_f32 v50, v56, v57
    v_cvt_pk_bf16_f32 v51, v58, v59
    buffer_store_dwordx4 v[48:51], v152, s[52:55], s60 offen offset:0 sc1
    v_pk_mul_f32 v[148:149], v[44:45], v[44:45]
    v_pk_mul_f32 v[150:151], v[46:47], v[46:47]
    v_pk_mul_f32 v[160:161], v[60:61], v[60:61]
    v_pk_mul_f32 v[162:163], v[62:63], v[62:63]
    v_pk_fma_f32 v[148:149], v[148:149], v[102:103], v[102:103] op_sel:[0,1,0] op_sel_hi:[1,1,0]
    v_pk_fma_f32 v[150:151], v[150:151], v[102:103], v[102:103] op_sel:[0,1,0] op_sel_hi:[1,1,0]
    v_pk_fma_f32 v[160:161], v[160:161], v[102:103], v[102:103] op_sel:[0,1,0] op_sel_hi:[1,1,0]
    v_pk_fma_f32 v[162:163], v[162:163], v[102:103], v[102:103] op_sel:[0,1,0] op_sel_hi:[1,1,0]
    v_pk_mul_f32 v[148:149], v[148:149], v[44:45]
    v_pk_mul_f32 v[150:151], v[150:151], v[46:47]
    v_pk_mul_f32 v[160:161], v[160:161], v[60:61]
    v_pk_mul_f32 v[162:163], v[162:163], v[62:63]
    v_exp_f32 v148, v148
    v_exp_f32 v149, v149
    v_exp_f32 v150, v150
    v_exp_f32 v151, v151
    v_exp_f32 v160, v160
    v_exp_f32 v161, v161
    v_exp_f32 v162, v162
    v_exp_f32 v163, v163
    v_pk_mul_f32 v[44:45], v[44:45], v[52:53]
    v_pk_mul_f32 v[46:47], v[46:47], v[54:55]
    v_pk_mul_f32 v[60:61], v[60:61], v[68:69]
    v_pk_mul_f32 v[62:63], v[62:63], v[70:71]
    v_pk_fma_f32 v[148:149], v[148:149], v[100:101], v[100:101] op_sel_hi:[1,0,0]
    v_pk_fma_f32 v[150:151], v[150:151], v[100:101], v[100:101] op_sel_hi:[1,0,0]
    v_pk_fma_f32 v[160:161], v[160:161], v[100:101], v[100:101] op_sel_hi:[1,0,0]
    v_pk_fma_f32 v[162:163], v[162:163], v[100:101], v[100:101] op_sel_hi:[1,0,0]
    v_rcp_f32 v148, v148
    v_rcp_f32 v149, v149
    v_rcp_f32 v150, v150
    v_rcp_f32 v151, v151
    v_rcp_f32 v160, v160
    v_rcp_f32 v161, v161
    v_rcp_f32 v162, v162
    v_rcp_f32 v163, v163
    v_pk_mul_f32 v[44:45], v[44:45], v[148:149]
    v_pk_mul_f32 v[46:47], v[46:47], v[150:151]
    v_pk_mul_f32 v[60:61], v[60:61], v[160:161]
    v_pk_mul_f32 v[62:63], v[62:63], v[162:163]
    v_cvt_pk_bf16_f32 v52, v44, v45
    v_cvt_pk_bf16_f32 v53, v46, v47
    v_cvt_pk_bf16_f32 v54, v60, v61
    v_cvt_pk_bf16_f32 v55, v62, v63
    buffer_store_dwordx4 v[52:55], v152, s[52:55], s60 offen offset:1024 sc1
    v_pk_fma_f32 v[88:89], v[144:145], v[96:97], v[88:89] op_sel:[0,1,0] op_sel_hi:[1,1,1]
    v_pk_fma_f32 v[90:91], v[146:147], v[96:97], v[90:91] op_sel:[0,1,0] op_sel_hi:[1,1,1]
    v_pk_fma_f32 v[92:93], v[144:145], v[100:101], v[92:93] op_sel:[0,1,0] op_sel_hi:[1,1,1]
    v_pk_fma_f32 v[94:95], v[146:147], v[100:101], v[94:95] op_sel:[0,1,0] op_sel_hi:[1,1,1]
    v_pk_fma_f32 v[72:73], v[136:137], v[96:97], v[72:73] op_sel:[0,1,0] op_sel_hi:[1,1,1]
    v_pk_fma_f32 v[74:75], v[138:139], v[96:97], v[74:75] op_sel:[0,1,0] op_sel_hi:[1,1,1]
    v_pk_fma_f32 v[76:77], v[136:137], v[100:101], v[76:77] op_sel:[0,1,0] op_sel_hi:[1,1,1]
    v_pk_fma_f32 v[78:79], v[138:139], v[100:101], v[78:79] op_sel:[0,1,0] op_sel_hi:[1,1,1]
    v_pk_fma_f32 v[80:81], v[140:141], v[96:97], v[80:81] op_sel:[0,1,0] op_sel_hi:[1,1,1]
    v_pk_fma_f32 v[82:83], v[142:143], v[96:97], v[82:83] op_sel:[0,1,0] op_sel_hi:[1,1,1]
    v_pk_fma_f32 v[84:85], v[140:141], v[100:101], v[84:85] op_sel:[0,1,0] op_sel_hi:[1,1,1]
    v_pk_fma_f32 v[86:87], v[142:143], v[100:101], v[86:87] op_sel:[0,1,0] op_sel_hi:[1,1,1]
    v_permlane32_swap_b32 v88, v92
    v_permlane32_swap_b32 v89, v93
    v_permlane32_swap_b32 v90, v94
    v_permlane32_swap_b32 v91, v95
    v_cmp_lt_u32 vcc, 31, v0
    s_nop 1
    v_cndmask_b32 v104, v96, v100, vcc
    v_cndmask_b32 v106, v98, v102, vcc
    v_cndmask_b32 v107, v99, v103, vcc
    v_pk_mul_f32 v[148:149], v[72:73], v[72:73]
    v_pk_mul_f32 v[150:151], v[74:75], v[74:75]
    v_pk_mul_f32 v[160:161], v[76:77], v[76:77]
    v_pk_mul_f32 v[162:163], v[78:79], v[78:79]
    v_pk_mul_f32 v[108:109], v[88:89], v[88:89]
    v_pk_mul_f32 v[110:111], v[90:91], v[90:91]
    v_pk_fma_f32 v[148:149], v[148:149], v[98:99], v[98:99] op_sel:[0,1,0] op_sel_hi:[1,1,0]
    v_pk_fma_f32 v[150:151], v[150:151], v[98:99], v[98:99] op_sel:[0,1,0] op_sel_hi:[1,1,0]
    v_pk_fma_f32 v[160:161], v[160:161], v[102:103], v[102:103] op_sel:[0,1,0] op_sel_hi:[1,1,0]
    v_pk_fma_f32 v[162:163], v[162:163], v[102:103], v[102:103] op_sel:[0,1,0] op_sel_hi:[1,1,0]
    v_pk_fma_f32 v[108:109], v[108:109], v[106:107], v[106:107] op_sel:[0,1,0] op_sel_hi:[1,1,0]
    v_pk_fma_f32 v[110:111], v[110:111], v[106:107], v[106:107] op_sel:[0,1,0] op_sel_hi:[1,1,0]
    v_pk_mul_f32 v[148:149], v[148:149], v[72:73]
    v_pk_mul_f32 v[150:151], v[150:151], v[74:75]
    v_pk_mul_f32 v[160:161], v[160:161], v[76:77]
    v_pk_mul_f32 v[162:163], v[162:163], v[78:79]
    v_pk_mul_f32 v[108:109], v[108:109], v[88:89]
    v_pk_mul_f32 v[110:111], v[110:111], v[90:91]
    v_exp_f32 v148, v148
    v_exp_f32 v149, v149
    v_exp_f32 v150, v150
    v_exp_f32 v151, v151
    v_exp_f32 v160, v160
    v_exp_f32 v161, v161
    v_exp_f32 v162, v162
    v_exp_f32 v163, v163
    v_exp_f32 v108, v108
    v_exp_f32 v109, v109
    v_exp_f32 v110, v110
    v_exp_f32 v111, v111
    v_pk_mul_f32 v[72:73], v[72:73], v[80:81]
    v_pk_mul_f32 v[74:75], v[74:75], v[82:83]
    v_pk_mul_f32 v[76:77], v[76:77], v[84:85]
    v_pk_mul_f32 v[78:79], v[78:79], v[86:87]
    v_pk_mul_f32 v[88:89], v[88:89], v[92:93]
    v_pk_mul_f32 v[90:91], v[90:91], v[94:95]
    v_pk_fma_f32 v[148:149], v[148:149], v[96:97], v[96:97] op_sel_hi:[1,0,0]
    v_pk_fma_f32 v[150:151], v[150:151], v[96:97], v[96:97] op_sel_hi:[1,0,0]
    v_pk_fma_f32 v[160:161], v[160:161], v[100:101], v[100:101] op_sel_hi:[1,0,0]
    v_pk_fma_f32 v[162:163], v[162:163], v[100:101], v[100:101] op_sel_hi:[1,0,0]
    v_pk_fma_f32 v[108:109], v[108:109], v[104:105], v[104:105] op_sel_hi:[1,0,0]
    v_pk_fma_f32 v[110:111], v[110:111], v[104:105], v[104:105] op_sel_hi:[1,0,0]
    v_rcp_f32 v148, v148
    v_rcp_f32 v149, v149
    v_rcp_f32 v150, v150
    v_rcp_f32 v151, v151
    v_rcp_f32 v160, v160
    v_rcp_f32 v161, v161
    v_rcp_f32 v162, v162
    v_rcp_f32 v163, v163
    v_rcp_f32 v108, v108
    v_rcp_f32 v109, v109
    v_rcp_f32 v110, v110
    v_rcp_f32 v111, v111
    v_pk_mul_f32 v[72:73], v[72:73], v[148:149]
    v_pk_mul_f32 v[74:75], v[74:75], v[150:151]
    v_pk_mul_f32 v[76:77], v[76:77], v[160:161]
    v_pk_mul_f32 v[78:79], v[78:79], v[162:163]
    v_pk_mul_f32 v[88:89], v[88:89], v[108:109]
    v_pk_mul_f32 v[90:91], v[90:91], v[110:111]
    v_cvt_pk_bf16_f32 v80, v72, v73
    v_cvt_pk_bf16_f32 v81, v74, v75
    v_cvt_pk_bf16_f32 v82, v76, v77
    v_cvt_pk_bf16_f32 v83, v78, v79
    v_cvt_pk_bf16_f32 v92, v88, v89
    v_cvt_pk_bf16_f32 v93, v90, v91
    buffer_store_dwordx4 v[80:83], v152, s[52:55], s61 offen sc1
    v_permlane32_swap_b32 v92, v94
    v_permlane32_swap_b32 v93, v95
    s_mov_b32 exec_hi, 0
    buffer_store_dwordx4 v[92:95], v152, s[52:55], s62 offen sc1
    s_mov_b64 exec, -1
    s_add_u32 s48, s34, 0x200000
    s_addc_u32 s49, s35, 0
    s_mov_b32 s50, 0x200000
    s_mov_b32 s51, 0x20000
    s_add_u32 s52, s34, 0x400000
    s_addc_u32 s53, s35, 0
    s_mov_b32 s54, 0x580000
    s_mov_b32 s55, 0x20000
    v_lshlrev_b32 v116, 4, v0
    s_lshl_b32 s4, s39, 5
    s_add_u32 s4, s4, s38
    s_lshl_b32 s56, s4, 10
    s_mul_i32 s58, s4, 2816
    s_lshr_b32 s60, s38, 6
    s_lshl_b32 s4, s37, 1
    s_add_u32 s4, s4, s40
    s_lshl_b32 s4, s4, 10
    s_add_u32 s56, s56, s4
    s_add_u32 s57, s56, 16384
    buffer_load_dwordx4 v[44:47], v116, s[48:51], s56 offen sc1
    buffer_load_dwordx4 v[48:51], v116, s[48:51], s57 offen sc1
    v_lshrrev_b32 v8, 2, v0
    v_bfe_u32 v9, v0, 3, 2
    s_lshl_b32 s4, s40, 1
    v_xor_b32 v9, s4, v9
    v_lshlrev_b32 v8, 7, v8
    v_lshl_add_u32 v8, v9, 5, v8
    v_and_b32 v9, 3, v0
    v_lshl_add_u32 v8, v9, 3, v8
    s_mul_i32 s4, s40, 73728
    v_add_u32 v117, s4, v8
    v_xor_b32 v118, 32, v117
    v_xor_b32 v119, 64, v117
    v_xor_b32 v120, 96, v117
    v_add_u32 v121, 65536, v117
    v_add_u32 v122, 65536, v118
    v_add_u32 v123, 65536, v119
    v_add_u32 v124, 65536, v120
    s_lshl_b32 s4, s3, 12
    s_add_u32 s5, s4, 16384
    v_add_u32 v125, s5, v116
    s_xor_b32 s4, s4, 8192
    s_add_u32 s5, s4, 16384
    v_add_u32 v126, s5, v116
    v_and_b32 v10, 1, v2
    s_mov_b32 s64, s30
    s_mov_b32 s65, s31
    s_mov_b32 s66, 0x200000
    s_mov_b32 s67, 0x20000
    s_lshl_b32 s4, s39, 5
    s_add_u32 s4, s4, s38
    v_add_u32 v127, s4, v1
    v_lshlrev_b32 v127, 10, v127
    v_lshl_add_u32 v127, v10, 5, v127
    v_lshrrev_b32 v8, 1, v2
    v_lshl_add_u32 v127, v8, 4, v127
    s_lshl_b32 s4, s37, 7
    s_lshl_b32 s5, s40, 6
    s_add_u32 s4, s4, s5
    v_add_u32 v127, s4, v127
    s_lshl_b32 s4, s39, 5
    v_add_u32 v8, s4, v1
    v_mul_u32_u24 v8, 272, v8
    v_lshl_add_u32 v8, v2, 4, v8
    s_mul_i32 s4, s40, 17536
    s_add_u32 s4, s4, 16384
    v_add_u32 v128, s4, v8
    s_mul_i32 s4, s40, 17280
    s_add_u32 s4, s4, 16512
    v_add_u32 v129, s4, v8
    v_lshrrev_b32 v8, 3, v0
    s_lshl_b32 s4, s3, 4
    v_add_u32 v8, s4, v8
    v_and_b32 v9, 7, v0
    v_mul_u32_u24 v130, 272, v8
    v_lshl_add_u32 v130, v9, 5, v130
    v_add_u32 v130, 16384, v130
    v_add_u32 v8, s38, v8
    v_lshlrev_b32 v127, 10, v8
    v_lshl_add_u32 v127, v9, 4, v127
    s_lshl_b32 s4, s37, 7
    v_add_u32 v127, s4, v127
    s_lshl_b32 s4, s40, 14
    s_add_u32 s68, s58, s4
    s_add_u32 s69, s68, 32768
    s_lshl_b32 s4, s40, 13
    s_add_u32 s70, s58, s4
    s_lshl_b32 s4, s40, 12
    s_add_u32 s71, s58, s4
    s_setprio 3
    s_lshl_b32 s6, s41, 13
    s_add_u32 s6, s6, 0x81800
    s_lshl_b32 s7, s36, 13
    s_and_b32 s5, s14, 15
    s_lshl_b32 s5, s5, 7
    s_add_u32 s7, s7, s5
    s_add_u32 s7, s7, 0x81800
    v_mov_b32 v7, 163584
    s_mov_b64 exec, 1
    s_waitcnt vmcnt(0) lgkmcnt(0)
    ds_add_rtn_u32 v6, v7, v5
    s_mov_b64 exec, 0xffff
    v_lshlrev_b32 v7, 7, v0
    s_waitcnt lgkmcnt(0)
    v_readfirstlane_b32 s5, v6
    s_nop 0
    s_cmp_lg_u32 s5, 11
    s_cbranch_scc1 L_55
    buffer_atomic_add v5, v7, s[44:47], s6 offen sc1
L_55:
    s_mov_b64 exec, -1
    v_lshlrev_b32 v12, 16, v44
    v_and_b32 v13, 0xffff0000, v44
    v_lshlrev_b32 v14, 16, v45
    v_and_b32 v15, 0xffff0000, v45
    v_lshlrev_b32 v16, 16, v46
    v_and_b32 v17, 0xffff0000, v46
    v_lshlrev_b32 v18, 16, v47
    v_and_b32 v19, 0xffff0000, v47
    v_lshlrev_b32 v28, 16, v48
    v_and_b32 v29, 0xffff0000, v48
    v_lshlrev_b32 v30, 16, v49
    v_and_b32 v31, 0xffff0000, v49
    v_lshlrev_b32 v32, 16, v50
    v_and_b32 v33, 0xffff0000, v50
    v_lshlrev_b32 v34, 16, v51
    v_and_b32 v35, 0xffff0000, v51
    s_cmp_lg_u32 s3, 0
    s_cbranch_scc1 L_56
    s_mov_b64 exec, 1
    s_mov_b32 s5, 0
    v_mov_b32 v6, 0
    buffer_atomic_add v6, v4, s[44:47], s7 offen sc0 sc1
    s_sleep 3
    v_mov_b32 v7, 0
    buffer_atomic_add v7, v4, s[44:47], s7 offen sc0 sc1
    s_sleep 3
    v_mov_b32 v175, 0
    buffer_atomic_add v175, v4, s[44:47], s7 offen sc0 sc1
L_58:
    s_waitcnt vmcnt(2)
    v_cmp_le_u32 vcc, 16, v6
    s_cbranch_vccnz L_57
    v_mov_b32 v6, 0
    buffer_atomic_add v6, v4, s[44:47], s7 offen sc0 sc1
    s_waitcnt vmcnt(2)
    v_cmp_le_u32 vcc, 16, v7
    s_cbranch_vccnz L_57
    v_mov_b32 v7, 0
    buffer_atomic_add v7, v4, s[44:47], s7 offen sc0 sc1
    s_waitcnt vmcnt(2)
    v_cmp_le_u32 vcc, 16, v175
    s_cbranch_vccnz L_57
    v_mov_b32 v175, 0
    buffer_atomic_add v175, v4, s[44:47], s7 offen sc0 sc1
    s_add_u32 s5, s5, 1
    s_cmp_lt_u32 s5, 50000
    s_cbranch_scc1 L_58
L_57:
    s_mov_b64 exec, -1
L_56:
    s_barrier
    s_add_u32 s59, s60, 0
    s_and_b32 s59, s59, 3
    s_lshl_b32 s59, s59, 12
    s_add_u32 s59, s59, s68
    buffer_load_dwordx4 v[52:55], v116, s[52:55], s59 offen sc1
    buffer_load_dwordx4 v[56:59], v116, s[52:55], s59 offen offset:1024 sc1
    buffer_load_dwordx4 v[60:63], v116, s[52:55], s59 offen offset:2048 sc1
    buffer_load_dwordx4 v[64:67], v116, s[52:55], s59 offen offset:3072 sc1
    s_add_u32 s59, s60, 1
    s_and_b32 s59, s59, 3
    s_lshl_b32 s59, s59, 12
    s_add_u32 s59, s59, s68
    buffer_load_dwordx4 v[68:71], v116, s[52:55], s59 offen sc1
    buffer_load_dwordx4 v[72:75], v116, s[52:55], s59 offen offset:1024 sc1
    buffer_load_dwordx4 v[76:79], v116, s[52:55], s59 offen offset:2048 sc1
    buffer_load_dwordx4 v[80:83], v116, s[52:55], s59 offen offset:3072 sc1
    s_add_u32 s59, s60, 2
    s_and_b32 s59, s59, 3
    s_lshl_b32 s59, s59, 12
    s_add_u32 s59, s59, s68
    buffer_load_dwordx4 v[84:87], v116, s[52:55], s59 offen sc1
    buffer_load_dwordx4 v[88:91], v116, s[52:55], s59 offen offset:1024 sc1
    buffer_load_dwordx4 v[92:95], v116, s[52:55], s59 offen offset:2048 sc1
    buffer_load_dwordx4 v[96:99], v116, s[52:55], s59 offen offset:3072 sc1
    ds_read_b64_tr_b16 a[0:1], v117 offset:0
    ds_read_b64_tr_b16 a[2:3], v117 offset:2048
    ds_read_b64_tr_b16 a[4:5], v118 offset:0
    ds_read_b64_tr_b16 a[6:7], v118 offset:2048
    ds_read_b64_tr_b16 a[8:9], v119 offset:0
    ds_read_b64_tr_b16 a[10:11], v119 offset:2048
    ds_read_b64_tr_b16 a[12:13], v120 offset:0
    ds_read_b64_tr_b16 a[14:15], v120 offset:2048
    ds_read_b64_tr_b16 a[16:17], v117 offset:4096
    ds_read_b64_tr_b16 a[18:19], v117 offset:6144
    ds_read_b64_tr_b16 a[20:21], v118 offset:4096
    ds_read_b64_tr_b16 a[22:23], v118 offset:6144
    ds_read_b64_tr_b16 a[24:25], v119 offset:4096
    ds_read_b64_tr_b16 a[26:27], v119 offset:6144
    ds_read_b64_tr_b16 a[28:29], v120 offset:4096
    ds_read_b64_tr_b16 a[30:31], v120 offset:6144
    s_waitcnt vmcnt(10) lgkmcnt(8)
    v_mfma_f32_16x16x32_bf16 v[12:15], a[0:3], v[52:55], v[12:15]
    ds_read_b64_tr_b16 a[32:33], v117 offset:8192
    s_add_u32 s59, s60, 3
    v_mfma_f32_16x16x32_bf16 v[16:19], a[4:7], v[52:55], v[16:19]
    ds_read_b64_tr_b16 a[34:35], v117 offset:10240
    s_and_b32 s59, s59, 3
    v_mfma_f32_16x16x32_bf16 v[20:23], a[8:11], v[52:55], 0
    ds_read_b64_tr_b16 a[36:37], v118 offset:8192
    s_lshl_b32 s59, s59, 12
    v_mfma_f32_16x16x32_bf16 v[24:27], a[12:15], v[52:55], 0
    ds_read_b64_tr_b16 a[38:39], v118 offset:10240
    s_add_u32 s59, s59, s68
    v_mfma_f32_16x16x32_bf16 v[28:31], a[0:3], v[56:59], v[28:31]
    ds_read_b64_tr_b16 a[40:41], v119 offset:8192
    buffer_load_dwordx4 v[100:103], v116, s[52:55], s59 offen sc1
    v_mfma_f32_16x16x32_bf16 v[32:35], a[4:7], v[56:59], v[32:35]
    ds_read_b64_tr_b16 a[42:43], v119 offset:10240
    buffer_load_dwordx4 v[104:107], v116, s[52:55], s59 offen offset:1024 sc1
    v_mfma_f32_16x16x32_bf16 v[36:39], a[8:11], v[56:59], 0
    ds_read_b64_tr_b16 a[44:45], v120 offset:8192
    buffer_load_dwordx4 v[108:111], v116, s[52:55], s59 offen offset:2048 sc1
    v_mfma_f32_16x16x32_bf16 v[40:43], a[12:15], v[56:59], 0
    ds_read_b64_tr_b16 a[46:47], v120 offset:10240
    buffer_load_dwordx4 v[112:115], v116, s[52:55], s59 offen offset:3072 sc1
    s_waitcnt vmcnt(12) lgkmcnt(8)
    v_mfma_f32_16x16x32_bf16 v[12:15], a[16:19], v[60:63], v[12:15]
    ds_read_b64_tr_b16 a[48:49], v117 offset:12288
    s_add_u32 s59, s60, 4
    v_mfma_f32_16x16x32_bf16 v[16:19], a[20:23], v[60:63], v[16:19]
    ds_read_b64_tr_b16 a[50:51], v117 offset:14336
    s_and_b32 s59, s59, 3
    v_mfma_f32_16x16x32_bf16 v[20:23], a[24:27], v[60:63], v[20:23]
    ds_read_b64_tr_b16 a[52:53], v118 offset:12288
    s_lshl_b32 s59, s59, 12
    v_mfma_f32_16x16x32_bf16 v[24:27], a[28:31], v[60:63], v[24:27]
    ds_read_b64_tr_b16 a[54:55], v118 offset:14336
    v_mfma_f32_16x16x32_bf16 v[28:31], a[16:19], v[64:67], v[28:31]
    ds_read_b64_tr_b16 a[56:57], v119 offset:12288
    s_add_u32 s59, s59, s69
    v_mfma_f32_16x16x32_bf16 v[32:35], a[20:23], v[64:67], v[32:35]
    ds_read_b64_tr_b16 a[58:59], v119 offset:14336
    buffer_load_dwordx4 v[52:55], v116, s[52:55], s59 offen sc1
    v_mfma_f32_16x16x32_bf16 v[36:39], a[24:27], v[64:67], v[36:39]
    ds_read_b64_tr_b16 a[60:61], v120 offset:12288
    buffer_load_dwordx4 v[56:59], v116, s[52:55], s59 offen offset:1024 sc1
    v_mfma_f32_16x16x32_bf16 v[40:43], a[28:31], v[64:67], v[40:43]
    ds_read_b64_tr_b16 a[62:63], v120 offset:14336
    s_waitcnt vmcnt(12) lgkmcnt(8)
    v_mfma_f32_16x16x32_bf16 v[12:15], a[32:35], v[68:71], v[12:15]
    ds_read_b64_tr_b16 a[0:1], v117 offset:16384
    buffer_load_dwordx4 v[60:63], v116, s[52:55], s59 offen offset:2048 sc1
    v_mfma_f32_16x16x32_bf16 v[16:19], a[36:39], v[68:71], v[16:19]
    ds_read_b64_tr_b16 a[2:3], v117 offset:18432
    v_mfma_f32_16x16x32_bf16 v[20:23], a[40:43], v[68:71], v[20:23]
    ds_read_b64_tr_b16 a[4:5], v118 offset:16384
    v_mfma_f32_16x16x32_bf16 v[24:27], a[44:47], v[68:71], v[24:27]
    ds_read_b64_tr_b16 a[6:7], v118 offset:18432
    v_mfma_f32_16x16x32_bf16 v[28:31], a[32:35], v[72:75], v[28:31]
    ds_read_b64_tr_b16 a[8:9], v119 offset:16384
    buffer_load_dwordx4 v[64:67], v116, s[52:55], s59 offen offset:3072 sc1
    v_mfma_f32_16x16x32_bf16 v[32:35], a[36:39], v[72:75], v[32:35]
    ds_read_b64_tr_b16 a[10:11], v119 offset:18432
    v_mfma_f32_16x16x32_bf16 v[36:39], a[40:43], v[72:75], v[36:39]
    ds_read_b64_tr_b16 a[12:13], v120 offset:16384
    v_mfma_f32_16x16x32_bf16 v[40:43], a[44:47], v[72:75], v[40:43]
    ds_read_b64_tr_b16 a[14:15], v120 offset:18432
    s_waitcnt vmcnt(12) lgkmcnt(8)
    v_mfma_f32_16x16x32_bf16 v[12:15], a[48:51], v[76:79], v[12:15]
    ds_read_b64_tr_b16 a[16:17], v117 offset:20480
    s_add_u32 s59, s60, 5
    v_mfma_f32_16x16x32_bf16 v[16:19], a[52:55], v[76:79], v[16:19]
    ds_read_b64_tr_b16 a[18:19], v117 offset:22528
    s_and_b32 s59, s59, 3
    v_mfma_f32_16x16x32_bf16 v[20:23], a[56:59], v[76:79], v[20:23]
    ds_read_b64_tr_b16 a[20:21], v118 offset:20480
    s_lshl_b32 s59, s59, 12
    v_mfma_f32_16x16x32_bf16 v[24:27], a[60:63], v[76:79], v[24:27]
    ds_read_b64_tr_b16 a[22:23], v118 offset:22528
    v_mfma_f32_16x16x32_bf16 v[28:31], a[48:51], v[80:83], v[28:31]
    ds_read_b64_tr_b16 a[24:25], v119 offset:20480
    s_add_u32 s59, s59, s69
    v_mfma_f32_16x16x32_bf16 v[32:35], a[52:55], v[80:83], v[32:35]
    ds_read_b64_tr_b16 a[26:27], v119 offset:22528
    buffer_load_dwordx4 v[68:71], v116, s[52:55], s59 offen sc1
    v_mfma_f32_16x16x32_bf16 v[36:39], a[56:59], v[80:83], v[36:39]
    ds_read_b64_tr_b16 a[28:29], v120 offset:20480
    buffer_load_dwordx4 v[72:75], v116, s[52:55], s59 offen offset:1024 sc1
    v_mfma_f32_16x16x32_bf16 v[40:43], a[60:63], v[80:83], v[40:43]
    ds_read_b64_tr_b16 a[30:31], v120 offset:22528
    s_barrier
    s_waitcnt vmcnt(12) lgkmcnt(8)
    v_mfma_f32_16x16x32_bf16 v[12:15], a[0:3], v[84:87], v[12:15]
    ds_read_b64_tr_b16 a[32:33], v117 offset:24576
    buffer_load_dwordx4 v[76:79], v116, s[52:55], s59 offen offset:2048 sc1
    v_mfma_f32_16x16x32_bf16 v[16:19], a[4:7], v[84:87], v[16:19]
    ds_read_b64_tr_b16 a[34:35], v117 offset:26624
    v_mfma_f32_16x16x32_bf16 v[20:23], a[8:11], v[84:87], v[20:23]
    ds_read_b64_tr_b16 a[36:37], v118 offset:24576
    v_mfma_f32_16x16x32_bf16 v[24:27], a[12:15], v[84:87], v[24:27]
    ds_read_b64_tr_b16 a[38:39], v118 offset:26624
    v_mfma_f32_16x16x32_bf16 v[28:31], a[0:3], v[88:91], v[28:31]
    ds_read_b64_tr_b16 a[40:41], v119 offset:24576
    buffer_load_dwordx4 v[80:83], v116, s[52:55], s59 offen offset:3072 sc1
    v_mfma_f32_16x16x32_bf16 v[32:35], a[4:7], v[88:91], v[32:35]
    ds_read_b64_tr_b16 a[42:43], v119 offset:26624
    v_mfma_f32_16x16x32_bf16 v[36:39], a[8:11], v[88:91], v[36:39]
    ds_read_b64_tr_b16 a[44:45], v120 offset:24576
    v_mfma_f32_16x16x32_bf16 v[40:43], a[12:15], v[88:91], v[40:43]
    ds_read_b64_tr_b16 a[46:47], v120 offset:26624
    s_waitcnt vmcnt(12) lgkmcnt(8)
    v_mfma_f32_16x16x32_bf16 v[12:15], a[16:19], v[92:95], v[12:15]
    ds_read_b64_tr_b16 a[48:49], v117 offset:28672
    s_add_u32 s59, s60, 6
    v_mfma_f32_16x16x32_bf16 v[16:19], a[20:23], v[92:95], v[16:19]
    ds_read_b64_tr_b16 a[50:51], v117 offset:30720
    s_and_b32 s59, s59, 3
    v_mfma_f32_16x16x32_bf16 v[20:23], a[24:27], v[92:95], v[20:23]
    ds_read_b64_tr_b16 a[52:53], v118 offset:28672
    s_lshl_b32 s59, s59, 12
    v_mfma_f32_16x16x32_bf16 v[24:27], a[28:31], v[92:95], v[24:27]
    ds_read_b64_tr_b16 a[54:55], v118 offset:30720
    v_mfma_f32_16x16x32_bf16 v[28:31], a[16:19], v[96:99], v[28:31]
    ds_read_b64_tr_b16 a[56:57], v119 offset:28672
    s_add_u32 s59, s59, s69
    v_mfma_f32_16x16x32_bf16 v[32:35], a[20:23], v[96:99], v[32:35]
    ds_read_b64_tr_b16 a[58:59], v119 offset:30720
    buffer_load_dwordx4 v[84:87], v116, s[52:55], s59 offen sc1
    v_mfma_f32_16x16x32_bf16 v[36:39], a[24:27], v[96:99], v[36:39]
    ds_read_b64_tr_b16 a[60:61], v120 offset:28672
    buffer_load_dwordx4 v[88:91], v116, s[52:55], s59 offen offset:1024 sc1
    v_mfma_f32_16x16x32_bf16 v[40:43], a[28:31], v[96:99], v[40:43]
    ds_read_b64_tr_b16 a[62:63], v120 offset:30720
    s_waitcnt vmcnt(12) lgkmcnt(8)
    v_mfma_f32_16x16x32_bf16 v[12:15], a[32:35], v[100:103], v[12:15]
    ds_read_b64_tr_b16 a[0:1], v117 offset:32768
    buffer_load_dwordx4 v[92:95], v116, s[52:55], s59 offen offset:2048 sc1
    v_mfma_f32_16x16x32_bf16 v[16:19], a[36:39], v[100:103], v[16:19]
    ds_read_b64_tr_b16 a[2:3], v117 offset:34816
    v_mfma_f32_16x16x32_bf16 v[20:23], a[40:43], v[100:103], v[20:23]
    ds_read_b64_tr_b16 a[4:5], v118 offset:32768
    v_mfma_f32_16x16x32_bf16 v[24:27], a[44:47], v[100:103], v[24:27]
    ds_read_b64_tr_b16 a[6:7], v118 offset:34816
    v_mfma_f32_16x16x32_bf16 v[28:31], a[32:35], v[104:107], v[28:31]
    ds_read_b64_tr_b16 a[8:9], v119 offset:32768
    buffer_load_dwordx4 v[96:99], v116, s[52:55], s59 offen offset:3072 sc1
    v_mfma_f32_16x16x32_bf16 v[32:35], a[36:39], v[104:107], v[32:35]
    ds_read_b64_tr_b16 a[10:11], v119 offset:34816
    v_mfma_f32_16x16x32_bf16 v[36:39], a[40:43], v[104:107], v[36:39]
    ds_read_b64_tr_b16 a[12:13], v120 offset:32768
    v_mfma_f32_16x16x32_bf16 v[40:43], a[44:47], v[104:107], v[40:43]
    ds_read_b64_tr_b16 a[14:15], v120 offset:34816
    s_waitcnt vmcnt(12) lgkmcnt(8)
    v_mfma_f32_16x16x32_bf16 v[12:15], a[48:51], v[108:111], v[12:15]
    ds_read_b64_tr_b16 a[16:17], v117 offset:36864
    s_add_u32 s59, s60, 7
    v_mfma_f32_16x16x32_bf16 v[16:19], a[52:55], v[108:111], v[16:19]
    ds_read_b64_tr_b16 a[18:19], v117 offset:38912
    s_and_b32 s59, s59, 3
    v_mfma_f32_16x16x32_bf16 v[20:23], a[56:59], v[108:111], v[20:23]
    ds_read_b64_tr_b16 a[20:21], v118 offset:36864
    s_lshl_b32 s59, s59, 12
    v_mfma_f32_16x16x32_bf16 v[24:27], a[60:63], v[108:111], v[24:27]
    ds_read_b64_tr_b16 a[22:23], v118 offset:38912
    v_mfma_f32_16x16x32_bf16 v[28:31], a[48:51], v[112:115], v[28:31]
    ds_read_b64_tr_b16 a[24:25], v119 offset:36864
    s_add_u32 s59, s59, s69
    v_mfma_f32_16x16x32_bf16 v[32:35], a[52:55], v[112:115], v[32:35]
    ds_read_b64_tr_b16 a[26:27], v119 offset:38912
    buffer_load_dwordx4 v[100:103], v116, s[52:55], s59 offen sc1
    v_mfma_f32_16x16x32_bf16 v[36:39], a[56:59], v[112:115], v[36:39]
    ds_read_b64_tr_b16 a[28:29], v120 offset:36864
    buffer_load_dwordx4 v[104:107], v116, s[52:55], s59 offen offset:1024 sc1
    v_mfma_f32_16x16x32_bf16 v[40:43], a[60:63], v[112:115], v[40:43]
    ds_read_b64_tr_b16 a[30:31], v120 offset:38912
    s_waitcnt vmcnt(12) lgkmcnt(8)
    v_mfma_f32_16x16x32_bf16 v[12:15], a[0:3], v[52:55], v[12:15]
    ds_read_b64_tr_b16 a[32:33], v117 offset:40960
    buffer_load_dwordx4 v[108:111], v116, s[52:55], s59 offen offset:2048 sc1
    v_mfma_f32_16x16x32_bf16 v[16:19], a[4:7], v[52:55], v[16:19]
    ds_read_b64_tr_b16 a[34:35], v117 offset:43008
    v_mfma_f32_16x16x32_bf16 v[20:23], a[8:11], v[52:55], v[20:23]
    ds_read_b64_tr_b16 a[36:37], v118 offset:40960
    v_mfma_f32_16x16x32_bf16 v[24:27], a[12:15], v[52:55], v[24:27]
    ds_read_b64_tr_b16 a[38:39], v118 offset:43008
    v_mfma_f32_16x16x32_bf16 v[28:31], a[0:3], v[56:59], v[28:31]
    ds_read_b64_tr_b16 a[40:41], v119 offset:40960
    buffer_load_dwordx4 v[112:115], v116, s[52:55], s59 offen offset:3072 sc1
    v_mfma_f32_16x16x32_bf16 v[32:35], a[4:7], v[56:59], v[32:35]
    ds_read_b64_tr_b16 a[42:43], v119 offset:43008
    v_mfma_f32_16x16x32_bf16 v[36:39], a[8:11], v[56:59], v[36:39]
    ds_read_b64_tr_b16 a[44:45], v120 offset:40960
    v_mfma_f32_16x16x32_bf16 v[40:43], a[12:15], v[56:59], v[40:43]
    ds_read_b64_tr_b16 a[46:47], v120 offset:43008
    s_waitcnt vmcnt(12) lgkmcnt(8)
    v_mfma_f32_16x16x32_bf16 v[12:15], a[16:19], v[60:63], v[12:15]
    ds_read_b64_tr_b16 a[48:49], v117 offset:45056
    s_add_u32 s59, s70, 65536
    v_mfma_f32_16x16x32_bf16 v[16:19], a[20:23], v[60:63], v[16:19]
    ds_read_b64_tr_b16 a[50:51], v117 offset:47104
    v_mfma_f32_16x16x32_bf16 v[20:23], a[24:27], v[60:63], v[20:23]
    ds_read_b64_tr_b16 a[52:53], v118 offset:45056
    buffer_load_dwordx4 v[52:55], v116, s[52:55], s59 offen sc1
    v_mfma_f32_16x16x32_bf16 v[24:27], a[28:31], v[60:63], v[24:27]
    ds_read_b64_tr_b16 a[54:55], v118 offset:47104
    v_mfma_f32_16x16x32_bf16 v[28:31], a[16:19], v[64:67], v[28:31]
    ds_read_b64_tr_b16 a[56:57], v119 offset:45056
    v_mfma_f32_16x16x32_bf16 v[32:35], a[20:23], v[64:67], v[32:35]
    ds_read_b64_tr_b16 a[58:59], v119 offset:47104
    buffer_load_dwordx4 v[56:59], v116, s[52:55], s59 offen offset:1024 sc1
    v_mfma_f32_16x16x32_bf16 v[36:39], a[24:27], v[64:67], v[36:39]
    ds_read_b64_tr_b16 a[60:61], v120 offset:45056
    v_mfma_f32_16x16x32_bf16 v[40:43], a[28:31], v[64:67], v[40:43]
    ds_read_b64_tr_b16 a[62:63], v120 offset:47104
    s_waitcnt vmcnt(12) lgkmcnt(8)
    v_mfma_f32_16x16x32_bf16 v[12:15], a[32:35], v[68:71], v[12:15]
    ds_read_b64_tr_b16 a[0:1], v117 offset:49152
    buffer_load_dwordx4 v[60:63], v116, s[52:55], s59 offen offset:2048 sc1
    v_mfma_f32_16x16x32_bf16 v[16:19], a[36:39], v[68:71], v[16:19]
    ds_read_b64_tr_b16 a[2:3], v117 offset:51200
    v_mfma_f32_16x16x32_bf16 v[20:23], a[40:43], v[68:71], v[20:23]
    ds_read_b64_tr_b16 a[4:5], v118 offset:49152
    v_mfma_f32_16x16x32_bf16 v[24:27], a[44:47], v[68:71], v[24:27]
    ds_read_b64_tr_b16 a[6:7], v118 offset:51200
    v_mfma_f32_16x16x32_bf16 v[28:31], a[32:35], v[72:75], v[28:31]
    ds_read_b64_tr_b16 a[8:9], v119 offset:49152
    buffer_load_dwordx4 v[64:67], v116, s[52:55], s59 offen offset:3072 sc1
    v_mfma_f32_16x16x32_bf16 v[32:35], a[36:39], v[72:75], v[32:35]
    ds_read_b64_tr_b16 a[10:11], v119 offset:51200
    v_mfma_f32_16x16x32_bf16 v[36:39], a[40:43], v[72:75], v[36:39]
    ds_read_b64_tr_b16 a[12:13], v120 offset:49152
    v_mfma_f32_16x16x32_bf16 v[40:43], a[44:47], v[72:75], v[40:43]
    ds_read_b64_tr_b16 a[14:15], v120 offset:51200
    s_waitcnt vmcnt(12) lgkmcnt(8)
    v_mfma_f32_16x16x32_bf16 v[12:15], a[48:51], v[76:79], v[12:15]
    ds_read_b64_tr_b16 a[16:17], v117 offset:53248
    s_add_u32 s59, s70, 69632
    v_mfma_f32_16x16x32_bf16 v[16:19], a[52:55], v[76:79], v[16:19]
    ds_read_b64_tr_b16 a[18:19], v117 offset:55296
    v_mfma_f32_16x16x32_bf16 v[20:23], a[56:59], v[76:79], v[20:23]
    ds_read_b64_tr_b16 a[20:21], v118 offset:53248
    buffer_load_dwordx4 v[68:71], v116, s[52:55], s59 offen sc1
    v_mfma_f32_16x16x32_bf16 v[24:27], a[60:63], v[76:79], v[24:27]
    ds_read_b64_tr_b16 a[22:23], v118 offset:55296
    v_mfma_f32_16x16x32_bf16 v[28:31], a[48:51], v[80:83], v[28:31]
    ds_read_b64_tr_b16 a[24:25], v119 offset:53248
    v_mfma_f32_16x16x32_bf16 v[32:35], a[52:55], v[80:83], v[32:35]
    ds_read_b64_tr_b16 a[26:27], v119 offset:55296
    buffer_load_dwordx4 v[72:75], v116, s[52:55], s59 offen offset:1024 sc1
    v_mfma_f32_16x16x32_bf16 v[36:39], a[56:59], v[80:83], v[36:39]
    ds_read_b64_tr_b16 a[28:29], v120 offset:53248
    v_mfma_f32_16x16x32_bf16 v[40:43], a[60:63], v[80:83], v[40:43]
    ds_read_b64_tr_b16 a[30:31], v120 offset:55296
    s_waitcnt vmcnt(12) lgkmcnt(8)
    v_mfma_f32_16x16x32_bf16 v[12:15], a[0:3], v[84:87], v[12:15]
    ds_read_b64_tr_b16 a[32:33], v117 offset:57344
    buffer_load_dwordx4 v[76:79], v116, s[52:55], s59 offen offset:2048 sc1
    v_mfma_f32_16x16x32_bf16 v[16:19], a[4:7], v[84:87], v[16:19]
    ds_read_b64_tr_b16 a[34:35], v117 offset:59392
    v_mfma_f32_16x16x32_bf16 v[20:23], a[8:11], v[84:87], v[20:23]
    ds_read_b64_tr_b16 a[36:37], v118 offset:57344
    v_mfma_f32_16x16x32_bf16 v[24:27], a[12:15], v[84:87], v[24:27]
    ds_read_b64_tr_b16 a[38:39], v118 offset:59392
    v_mfma_f32_16x16x32_bf16 v[28:31], a[0:3], v[88:91], v[28:31]
    ds_read_b64_tr_b16 a[40:41], v119 offset:57344
    buffer_load_dwordx4 v[80:83], v116, s[52:55], s59 offen offset:3072 sc1
    v_mfma_f32_16x16x32_bf16 v[32:35], a[4:7], v[88:91], v[32:35]
    ds_read_b64_tr_b16 a[42:43], v119 offset:59392
    v_mfma_f32_16x16x32_bf16 v[36:39], a[8:11], v[88:91], v[36:39]
    ds_read_b64_tr_b16 a[44:45], v120 offset:57344
    v_mfma_f32_16x16x32_bf16 v[40:43], a[12:15], v[88:91], v[40:43]
    ds_read_b64_tr_b16 a[46:47], v120 offset:59392
    s_waitcnt vmcnt(12) lgkmcnt(8)
    v_mfma_f32_16x16x32_bf16 v[12:15], a[16:19], v[92:95], v[12:15]
    ds_read_b64_tr_b16 a[48:49], v117 offset:61440
    s_add_u32 s59, s71, 81920
    v_mfma_f32_16x16x32_bf16 v[16:19], a[20:23], v[92:95], v[16:19]
    ds_read_b64_tr_b16 a[50:51], v117 offset:63488
    v_mfma_f32_16x16x32_bf16 v[20:23], a[24:27], v[92:95], v[20:23]
    ds_read_b64_tr_b16 a[52:53], v118 offset:61440
    buffer_load_dwordx4 v[84:87], v116, s[52:55], s59 offen sc1
    v_mfma_f32_16x16x32_bf16 v[24:27], a[28:31], v[92:95], v[24:27]
    ds_read_b64_tr_b16 a[54:55], v118 offset:63488
    v_mfma_f32_16x16x32_bf16 v[28:31], a[16:19], v[96:99], v[28:31]
    ds_read_b64_tr_b16 a[56:57], v119 offset:61440
    v_mfma_f32_16x16x32_bf16 v[32:35], a[20:23], v[96:99], v[32:35]
    ds_read_b64_tr_b16 a[58:59], v119 offset:63488
    buffer_load_dwordx4 v[88:91], v116, s[52:55], s59 offen offset:1024 sc1
    v_mfma_f32_16x16x32_bf16 v[36:39], a[24:27], v[96:99], v[36:39]
    ds_read_b64_tr_b16 a[60:61], v120 offset:61440
    v_mfma_f32_16x16x32_bf16 v[40:43], a[28:31], v[96:99], v[40:43]
    ds_read_b64_tr_b16 a[62:63], v120 offset:63488
    s_barrier
    s_waitcnt vmcnt(12) lgkmcnt(8)
    v_mfma_f32_16x16x32_bf16 v[12:15], a[32:35], v[100:103], v[12:15]
    ds_read_b64_tr_b16 a[0:1], v121 offset:0
    buffer_load_dwordx4 v[92:95], v116, s[52:55], s59 offen offset:2048 sc1
    v_mfma_f32_16x16x32_bf16 v[16:19], a[36:39], v[100:103], v[16:19]
    ds_read_b64_tr_b16 a[2:3], v121 offset:2048
    v_mfma_f32_16x16x32_bf16 v[20:23], a[40:43], v[100:103], v[20:23]
    ds_read_b64_tr_b16 a[4:5], v122 offset:0
    v_mfma_f32_16x16x32_bf16 v[24:27], a[44:47], v[100:103], v[24:27]
    ds_read_b64_tr_b16 a[6:7], v122 offset:2048
    v_mfma_f32_16x16x32_bf16 v[28:31], a[32:35], v[104:107], v[28:31]
    ds_read_b64_tr_b16 a[8:9], v123 offset:0
    buffer_load_dwordx4 v[96:99], v116, s[52:55], s59 offen offset:3072 sc1
    v_mfma_f32_16x16x32_bf16 v[32:35], a[36:39], v[104:107], v[32:35]
    ds_read_b64_tr_b16 a[10:11], v123 offset:2048
    v_mfma_f32_16x16x32_bf16 v[36:39], a[40:43], v[104:107], v[36:39]
    ds_read_b64_tr_b16 a[12:13], v124 offset:0
    v_mfma_f32_16x16x32_bf16 v[40:43], a[44:47], v[104:107], v[40:43]
    ds_read_b64_tr_b16 a[14:15], v124 offset:2048
    s_waitcnt vmcnt(12) lgkmcnt(8)
    v_mfma_f32_16x16x32_bf16 v[12:15], a[48:51], v[108:111], v[12:15]
    ds_read_b64_tr_b16 a[16:17], v121 offset:4096
    v_mfma_f32_16x16x32_bf16 v[16:19], a[52:55], v[108:111], v[16:19]
    ds_read_b64_tr_b16 a[18:19], v121 offset:6144
    v_mfma_f32_16x16x32_bf16 v[20:23], a[56:59], v[108:111], v[20:23]
    ds_read_b64_tr_b16 a[20:21], v122 offset:4096
    v_mfma_f32_16x16x32_bf16 v[24:27], a[60:63], v[108:111], v[24:27]
    ds_read_b64_tr_b16 a[22:23], v122 offset:6144
    v_mfma_f32_16x16x32_bf16 v[28:31], a[48:51], v[112:115], v[28:31]
    ds_read_b64_tr_b16 a[24:25], v123 offset:4096
    v_mfma_f32_16x16x32_bf16 v[32:35], a[52:55], v[112:115], v[32:35]
    ds_read_b64_tr_b16 a[26:27], v123 offset:6144
    v_mfma_f32_16x16x32_bf16 v[36:39], a[56:59], v[112:115], v[36:39]
    ds_read_b64_tr_b16 a[28:29], v124 offset:4096
    v_mfma_f32_16x16x32_bf16 v[40:43], a[60:63], v[112:115], v[40:43]
    ds_read_b64_tr_b16 a[30:31], v124 offset:6144
    s_waitcnt vmcnt(10) lgkmcnt(8)
    v_swap_b32 v54, v56
    v_swap_b32 v55, v57
    s_nop 1
    v_mfma_f32_16x16x32_bf16 v[12:15], a[0:3], v[52:55], v[12:15]
    ds_read_b64_tr_b16 a[32:33], v117 offset:0
    v_mfma_f32_16x16x32_bf16 v[16:19], a[4:7], v[52:55], v[16:19]
    ds_read_b64_tr_b16 a[34:35], v117 offset:2048
    v_mfma_f32_16x16x32_bf16 v[20:23], a[8:11], v[52:55], v[20:23]
    ds_read_b64_tr_b16 a[36:37], v118 offset:0
    v_mfma_f32_16x16x32_bf16 v[24:27], a[12:15], v[52:55], v[24:27]
    ds_read_b64_tr_b16 a[38:39], v118 offset:2048
    v_mfma_f32_16x16x32_bf16 v[28:31], a[0:3], v[56:59], v[28:31]
    ds_read_b64_tr_b16 a[40:41], v119 offset:0
    v_mfma_f32_16x16x32_bf16 v[32:35], a[4:7], v[56:59], v[32:35]
    ds_read_b64_tr_b16 a[42:43], v119 offset:2048
    v_mfma_f32_16x16x32_bf16 v[36:39], a[8:11], v[56:59], v[36:39]
    ds_read_b64_tr_b16 a[44:45], v120 offset:0
    v_mfma_f32_16x16x32_bf16 v[40:43], a[12:15], v[56:59], v[40:43]
    ds_read_b64_tr_b16 a[46:47], v120 offset:2048
    s_waitcnt vmcnt(8) lgkmcnt(8)
    v_swap_b32 v62, v64
    v_swap_b32 v63, v65
    s_nop 1
    v_mfma_f32_16x16x32_bf16 v[12:15], a[16:19], v[60:63], v[12:15]
    ds_read_b64_tr_b16 a[48:49], v117 offset:4096
    v_mfma_f32_16x16x32_bf16 v[16:19], a[20:23], v[60:63], v[16:19]
    ds_read_b64_tr_b16 a[50:51], v117 offset:6144
    v_mfma_f32_16x16x32_bf16 v[20:23], a[24:27], v[60:63], v[20:23]
    ds_read_b64_tr_b16 a[52:53], v118 offset:4096
    v_mfma_f32_16x16x32_bf16 v[24:27], a[28:31], v[60:63], v[24:27]
    ds_read_b64_tr_b16 a[54:55], v118 offset:6144
    v_mfma_f32_16x16x32_bf16 v[28:31], a[16:19], v[64:67], v[28:31]
    ds_read_b64_tr_b16 a[56:57], v119 offset:4096
    v_mfma_f32_16x16x32_bf16 v[32:35], a[20:23], v[64:67], v[32:35]
    ds_read_b64_tr_b16 a[58:59], v119 offset:6144
    v_mfma_f32_16x16x32_bf16 v[36:39], a[24:27], v[64:67], v[36:39]
    ds_read_b64_tr_b16 a[60:61], v120 offset:4096
    v_mfma_f32_16x16x32_bf16 v[40:43], a[28:31], v[64:67], v[40:43]
    ds_read_b64_tr_b16 a[62:63], v120 offset:6144
    s_waitcnt vmcnt(6) lgkmcnt(8)
    v_swap_b32 v70, v72
    v_swap_b32 v71, v73
    s_nop 1
    v_mfma_f32_16x16x32_bf16 v[12:15], a[32:35], v[68:71], v[12:15]
    ds_read_b64_tr_b16 a[0:1], v117 offset:8192
    v_mfma_f32_16x16x32_bf16 v[16:19], a[36:39], v[68:71], v[16:19]
    ds_read_b64_tr_b16 a[2:3], v117 offset:10240
    v_mfma_f32_16x16x32_bf16 v[20:23], a[40:43], v[68:71], v[20:23]
    ds_read_b64_tr_b16 a[4:5], v118 offset:8192
    v_mfma_f32_16x16x32_bf16 v[24:27], a[44:47], v[68:71], v[24:27]
    ds_read_b64_tr_b16 a[6:7], v118 offset:10240
    v_mfma_f32_16x16x32_bf16 v[28:31], a[32:35], v[72:75], v[28:31]
    ds_read_b64_tr_b16 a[8:9], v119 offset:8192
    v_mfma_f32_16x16x32_bf16 v[32:35], a[36:39], v[72:75], v[32:35]
    ds_read_b64_tr_b16 a[10:11], v119 offset:10240
    v_mfma_f32_16x16x32_bf16 v[36:39], a[40:43], v[72:75], v[36:39]
    ds_read_b64_tr_b16 a[12:13], v120 offset:8192
    v_mfma_f32_16x16x32_bf16 v[40:43], a[44:47], v[72:75], v[40:43]
    ds_read_b64_tr_b16 a[14:15], v120 offset:10240
    s_waitcnt vmcnt(4) lgkmcnt(8)
    v_swap_b32 v78, v80
    v_swap_b32 v79, v81
    s_nop 1
    v_mfma_f32_16x16x32_bf16 v[12:15], a[48:51], v[76:79], v[12:15]
    ds_read_b64_tr_b16 a[16:17], v117 offset:12288
    v_mfma_f32_16x16x32_bf16 v[16:19], a[52:55], v[76:79], v[16:19]
    ds_read_b64_tr_b16 a[18:19], v117 offset:14336
    v_mfma_f32_16x16x32_bf16 v[20:23], a[56:59], v[76:79], v[20:23]
    ds_read_b64_tr_b16 a[20:21], v118 offset:12288
    v_mfma_f32_16x16x32_bf16 v[24:27], a[60:63], v[76:79], v[24:27]
    ds_read_b64_tr_b16 a[22:23], v118 offset:14336
    v_mfma_f32_16x16x32_bf16 v[28:31], a[48:51], v[80:83], v[28:31]
    ds_read_b64_tr_b16 a[24:25], v119 offset:12288
    v_mfma_f32_16x16x32_bf16 v[32:35], a[52:55], v[80:83], v[32:35]
    ds_read_b64_tr_b16 a[26:27], v119 offset:14336
    v_mfma_f32_16x16x32_bf16 v[36:39], a[56:59], v[80:83], v[36:39]
    ds_read_b64_tr_b16 a[28:29], v120 offset:12288
    v_mfma_f32_16x16x32_bf16 v[40:43], a[60:63], v[80:83], v[40:43]
    ds_read_b64_tr_b16 a[30:31], v120 offset:14336
    s_waitcnt vmcnt(2) lgkmcnt(8)
    v_swap_b32 v86, v88
    v_swap_b32 v87, v89
    s_nop 1
    v_mfma_f32_16x16x32_bf16 v[12:15], a[0:3], v[84:87], v[12:15]
    v_mfma_f32_16x16x32_bf16 v[16:19], a[4:7], v[84:87], v[16:19]
    v_mfma_f32_16x16x32_bf16 v[20:23], a[8:11], v[84:87], v[20:23]
    v_mfma_f32_16x16x32_bf16 v[24:27], a[12:15], v[84:87], v[24:27]
    v_mfma_f32_16x16x32_bf16 v[28:31], a[0:3], v[88:91], v[28:31]
    v_mfma_f32_16x16x32_bf16 v[32:35], a[4:7], v[88:91], v[32:35]
    v_mfma_f32_16x16x32_bf16 v[36:39], a[8:11], v[88:91], v[36:39]
    v_mfma_f32_16x16x32_bf16 v[40:43], a[12:15], v[88:91], v[40:43]
    s_waitcnt vmcnt(0) lgkmcnt(0)
    v_swap_b32 v94, v96
    v_swap_b32 v95, v97
    s_nop 1
    v_mfma_f32_16x16x32_bf16 v[12:15], a[16:19], v[92:95], v[12:15]
    v_mfma_f32_16x16x32_bf16 v[16:19], a[20:23], v[92:95], v[16:19]
    v_mfma_f32_16x16x32_bf16 v[20:23], a[24:27], v[92:95], v[20:23]
    v_mfma_f32_16x16x32_bf16 v[24:27], a[28:31], v[92:95], v[24:27]
    v_mfma_f32_16x16x32_bf16 v[28:31], a[16:19], v[96:99], v[28:31]
    v_mfma_f32_16x16x32_bf16 v[32:35], a[20:23], v[96:99], v[32:35]
    v_mfma_f32_16x16x32_bf16 v[36:39], a[24:27], v[96:99], v[36:39]
    v_mfma_f32_16x16x32_bf16 v[40:43], a[28:31], v[96:99], v[40:43]
    s_nop 0
    ds_write_b128 v128, v[12:15] offset:0
    ds_write_b128 v128, v[16:19] offset:64
    ds_write_b128 v129, v[20:23] offset:0
    ds_write_b128 v129, v[24:27] offset:64
    ds_write_b128 v128, v[28:31] offset:4352
    ds_write_b128 v128, v[32:35] offset:4416
    ds_write_b128 v129, v[36:39] offset:4352
    ds_write_b128 v129, v[40:43] offset:4416
    s_waitcnt lgkmcnt(0)
    s_barrier
    ds_read_b128 v[12:15], v130 offset:0
    ds_read_b128 v[16:19], v130 offset:16
    ds_read_b128 v[20:23], v130 offset:17408
    ds_read_b128 v[24:27], v130 offset:17424
    ds_read_b128 v[28:31], v130 offset:2176
    ds_read_b128 v[32:35], v130 offset:2192
    ds_read_b128 v[36:39], v130 offset:19584
    ds_read_b128 v[40:43], v130 offset:19600
    s_waitcnt lgkmcnt(4)
    v_pk_add_f32 v[12:13], v[12:13], v[20:21]
    v_pk_add_f32 v[14:15], v[14:15], v[22:23]
    v_pk_add_f32 v[16:17], v[16:17], v[24:25]
    v_pk_add_f32 v[18:19], v[18:19], v[26:27]
    v_cvt_pk_bf16_f32 v44, v12, v13
    v_cvt_pk_bf16_f32 v45, v14, v15
    v_cvt_pk_bf16_f32 v46, v16, v17
    v_cvt_pk_bf16_f32 v47, v18, v19
    s_mov_b32 s4, 0
    buffer_store_dwordx4 v[44:47], v127, s[64:67], s4 offen sc1
    s_waitcnt lgkmcnt(0)
    v_pk_add_f32 v[28:29], v[28:29], v[36:37]
    v_pk_add_f32 v[30:31], v[30:31], v[38:39]
    v_pk_add_f32 v[32:33], v[32:33], v[40:41]
    v_pk_add_f32 v[34:35], v[34:35], v[42:43]
    v_cvt_pk_bf16_f32 v48, v28, v29
    v_cvt_pk_bf16_f32 v49, v30, v31
    v_cvt_pk_bf16_f32 v50, v32, v33
    v_cvt_pk_bf16_f32 v51, v34, v35
    s_mov_b32 s4, 8192
    buffer_store_dwordx4 v[48:51], v127, s[64:67], s4 offen sc1
    s_endpgm
.p2align 6
L_h2:
    s_lshr_b32 s6, s14, 4
    s_lshl_b32 s36, s13, 1
    s_add_u32 s36, s36, s6
    s_and_b32 s37, s14, 7
    s_lshr_b32 s6, s14, 3
    s_lshl_b32 s4, s13, 2
    s_add_u32 s6, s6, s4
    s_lshl_b32 s38, s6, 6
    s_lshr_b32 s4, s13, 2
    s_lshl_b32 s4, s4, 3
    s_lshr_b32 s5, s14, 2
    s_add_u32 s41, s4, s5
    s_and_b32 s4, s13, 3
    s_lshl_b32 s4, s4, 2
    s_and_b32 s5, s14, 3
    s_add_u32 s42, s4, s5
    v_mov_b32 v4, 0
    v_mov_b32 v5, 1
    s_add_u32 s44, s34, 0xa00000
    s_addc_u32 s45, s35, 0
    s_mov_b32 s46, 0x100000
    s_mov_b32 s47, 0x20000
    s_mul_i32 s78, s42, 176
    s_lshl_b32 s4, s41, 1
    s_add_u32 s4, s4, s39
    s_mul_i32 s4, s4, 44032
    s_add_u32 s4, s4, s78
    v_add_u32 v13, 0, v0
    v_mul_u32_u24 v14, 5462, v13
    v_lshrrev_b32 v14, 16, v14
    v_mul_u32_u24 v15, 12, v14
    v_sub_u32 v13, v13, v15
    v_lshrrev_b32 v15, 1, v14
    v_and_b32 v15, 2, v15
    v_xor_b32 v13, v13, v15
    v_min_u32 v13, 10, v13
    v_lshlrev_b32 v13, 4, v13
    v_mul_u32_u24 v14, 2752, v14
    v_add3_u32 v56, v13, v14, s4
    v_add_u32 v13, 64, v0
    v_mul_u32_u24 v14, 5462, v13
    v_lshrrev_b32 v14, 16, v14
    v_mul_u32_u24 v15, 12, v14
    v_sub_u32 v13, v13, v15
    v_lshrrev_b32 v15, 1, v14
    v_and_b32 v15, 2, v15
    v_xor_b32 v13, v13, v15
    v_min_u32 v13, 10, v13
    v_lshlrev_b32 v13, 4, v13
    v_mul_u32_u24 v14, 2752, v14
    v_add3_u32 v57, v13, v14, s4
    v_subrev_u32 v57, 1024, v57
    v_add_u32 v13, 128, v0
    v_mul_u32_u24 v14, 5462, v13
    v_lshrrev_b32 v14, 16, v14
    v_mul_u32_u24 v15, 12, v14
    v_sub_u32 v13, v13, v15
    v_lshrrev_b32 v15, 1, v14
    v_and_b32 v15, 2, v15
    v_xor_b32 v13, v13, v15
    v_min_u32 v13, 10, v13
    v_lshlrev_b32 v13, 4, v13
    v_mul_u32_u24 v14, 2752, v14
    v_add3_u32 v58, v13, v14, s4
    v_subrev_u32 v58, 2048, v58
    v_lshrrev_b32 v88, 3, v0
    v_and_b32 v89, 6, v88
    v_and_b32 v90, 7, v0
    v_xor_b32 v89, v90, v89
    v_lshlrev_b32 v88, 10, v88
    s_lshl_b32 s4, s37, 7
    v_add_u32 v88, s4, v88
    v_lshl_add_u32 v90, v89, 4, v88
    s_lshl_b32 s64, s37, 7
    s_mul_i32 s4, s3, 16
    s_add_u32 s4, s4, s38
    v_lshrrev_b32 v91, 3, v0
    v_add_u32 v91, s4, v91
    v_mul_u32_u24 v91, 1024, v91
    v_add_u32 v91, s64, v91
    v_and_b32 v92, 7, v0
    v_xor_b32 v92, v92, v2
    v_lshl_add_u32 v93, v92, 4, v91
    v_xor_b32 v92, 4, v92
    v_lshl_add_u32 v94, v92, 4, v91
    v_add_u32 v94, 7168, v94
    s_mov_b32 s68, s20
    s_mov_b32 s69, s21
    s_mov_b32 s70, 524288
    s_mov_b32 s71, 0x20000
    s_lshr_b32 s4, s38, 6
    s_add_u32 s65, s37, s4
    s_lshl_b32 s4, s3, 14
    v_add_u32 v59, s4, v90
    s_mul_i32 s5, s40, 57344
    v_add_u32 v61, s5, v59
    s_mul_i32 s4, s3, 90112
    s_add_u32 s5, s4, 32768
    v_add_u32 v63, s5, v90
    s_lshl_b32 s4, s4, 1
    s_add_u32 s4, s4, 81920
    v_add_u32 v65, s4, v90
    v_add_u32 v60, 7168, v59
    v_add_u32 v62, 7168, v61
    v_add_u32 v64, 7168, v63
    v_add_u32 v66, 89088, v65
    v_lshlrev_b32 v20, 4, v0
    s_add_u32 s80, s34, 0xc00000
    s_addc_u32 s81, s35, 0
    s_mov_b32 s82, 2883584
    s_mov_b32 s83, 0x20000
    s_mul_i32 s84, s42, 180224
    s_mul_i32 s85, s3, 5120
    s_add_u32 s86, s52, 20480
    s_lshl_b32 s77, s42, 7
    s_add_u32 s77, s77, 0x80000
    s_mov_b32 s75, 0x20000
    s_mov_b32 s88, s32
    s_mov_b32 s89, s33
    s_mov_b32 s90, 256
    s_mov_b32 s91, 0x20000
    v_lshrrev_b32 v13, 2, v0
    v_mul_u32_u24 v13, 192, v13
    v_and_b32 v14, 3, v0
    v_lshl_add_u32 v13, v14, 3, v13
    s_mul_i32 s4, s39, 6144
    s_add_u32 s4, s4, 110592
    v_add_u32 v13, s4, v13
    v_and_b32 v15, 1, v2
    v_xor_b32 v69, s40, v15
    v_lshl_add_u32 v69, v69, 5, v13
    s_add_u32 s4, s40, 3
    v_xor_b32 v70, s4, v15
    v_lshl_add_u32 v70, v70, 5, v13
    s_mul_i32 s4, s40, 3
    s_add_u32 s4, s4, 2
    v_xor_b32 v71, s4, v15
    v_lshl_add_u32 v71, v71, 5, v13
    v_lshrrev_b32 v14, 1, v14
    s_cmp_eq_u32 s3, 2
    s_cselect_b32 s4, 6128, 0
    v_mul_u32_u24 v14, s4, v14
    v_add_u32 v71, v71, v14
    v_mov_b32 v36, 0x3f803f80
    v_mov_b32 v37, 0x3f803f80
    v_mov_b32 v38, 0x3f803f80
    v_mov_b32 v39, 0x3f803f80
    s_add_u32 m0, s50, 48128
    s_nop 0
    buffer_load_dwordx4 v17, s[60:63], s55 offen  lds
    buffer_load_dwordx4 v17, s[60:63], s55 offen offset:1024  lds
    buffer_load_dwordx4 v17, s[60:63], s55 offen offset:2048  lds
    s_cmp_ge_u32 s3, 2
    s_cbranch_scc1 L_2
    s_add_u32 m0, s52, 34816
    s_mov_b32 exec_lo, s23
    s_nop 0
    buffer_load_dwordx4 v12, s[56:59], s54 offen lds
    s_mov_b32 exec_lo, -1
L_2:
    s_waitcnt vmcnt(8)
    s_barrier
    s_add_u32 s54, s49, 2
    s_and_b32 s54, s54, 7
    s_mul_i32 s55, s54, 196608
    s_lshl_b32 s54, s54, 7
    s_add_u32 m0, s53, 71680
    s_nop 0
    buffer_load_dwordx4 v10, s[56:59], s54 offen  lds
    buffer_load_dwordx4 v11, s[56:59], s54 offen offset:1024  lds
    s_add_u32 m0, s50, 79872
    s_nop 0
    buffer_load_dwordx4 v16, s[60:63], s55 offen  lds
    buffer_load_dwordx4 v16, s[60:63], s55 offen offset:1024  lds
    buffer_load_dwordx4 v16, s[60:63], s55 offen offset:2048  lds
    s_add_u32 m0, s50, 82944
    s_nop 0
    buffer_load_dwordx4 v17, s[60:63], s55 offen  lds
    buffer_load_dwordx4 v17, s[60:63], s55 offen offset:1024  lds
    buffer_load_dwordx4 v17, s[60:63], s55 offen offset:2048  lds
    s_cmp_ge_u32 s3, 2
    s_cbranch_scc1 L_3
    s_add_u32 m0, s52, 69632
    s_mov_b32 exec_lo, s23
    s_nop 0
    buffer_load_dwordx4 v12, s[56:59], s54 offen lds
    s_mov_b32 exec_lo, -1
L_3:
    s_waitcnt vmcnt(8)
    s_barrier
    s_add_u32 s54, s49, 3
    s_and_b32 s54, s54, 7
    s_mul_i32 s55, s54, 196608
    s_lshl_b32 s54, s54, 7
    s_add_u32 m0, s53, 2048
    s_nop 0
    buffer_load_dwordx4 v10, s[56:59], s54 offen  lds
    buffer_load_dwordx4 v11, s[56:59], s54 offen offset:1024  lds
    s_add_u32 m0, s50, 10240
    s_nop 0
    buffer_load_dwordx4 v16, s[60:63], s55 offen  lds
    buffer_load_dwordx4 v16, s[60:63], s55 offen offset:1024  lds
    buffer_load_dwordx4 v16, s[60:63], s55 offen offset:2048  lds
    s_add_u32 m0, s50, 13312
    s_nop 0
    buffer_load_dwordx4 v17, s[60:63], s55 offen  lds
    buffer_load_dwordx4 v17, s[60:63], s55 offen offset:1024  lds
    buffer_load_dwordx4 v17, s[60:63], s55 offen offset:2048  lds
    s_cmp_ge_u32 s3, 2
    s_cbranch_scc1 L_4
    s_add_u32 m0, s52, 0
    s_mov_b32 exec_lo, s23
    s_nop 0
    buffer_load_dwordx4 v12, s[56:59], s54 offen lds
    s_mov_b32 exec_lo, -1
L_4:
    s_cmp_lg_u32 s40, 0
    s_cselect_b32 s72, s26, s24
    s_cselect_b32 s73, s27, s25
    s_mov_b32 s74, 1409024
    s_mov_b32 s75, 0x20000
    s_mul_i32 s55, s3, 3072
    s_add_u32 m0, s55, 110592
    s_nop 0
    buffer_load_dwordx4 v56, s[72:75], 0 offen  lds
    buffer_load_dwordx4 v57, s[72:75], 0 offen offset:1024  lds
    buffer_load_dwordx4 v58, s[72:75], 0 offen offset:2048  lds
    s_waitcnt vmcnt(11)
    s_barrier
    s_add_u32 s54, s49, 4
    s_and_b32 s54, s54, 7
    s_mul_i32 s55, s54, 196608
    s_lshl_b32 s54, s54, 7
    s_add_u32 m0, s53, 36864
    s_nop 0
    buffer_load_dwordx4 v10, s[56:59], s54 offen  lds
    buffer_load_dwordx4 v11, s[56:59], s54 offen offset:1024  lds
    s_add_u32 m0, s50, 45056
    s_nop 0
    buffer_load_dwordx4 v16, s[60:63], s55 offen  lds
    buffer_load_dwordx4 v16, s[60:63], s55 offen offset:1024  lds
    buffer_load_dwordx4 v16, s[60:63], s55 offen offset:2048  lds
    s_add_u32 m0, s50, 48128
    s_nop 0
    buffer_load_dwordx4 v17, s[60:63], s55 offen  lds
    buffer_load_dwordx4 v17, s[60:63], s55 offen offset:1024  lds
    buffer_load_dwordx4 v17, s[60:63], s55 offen offset:2048  lds
    s_cmp_ge_u32 s3, 2
    s_cbranch_scc1 L_5
    s_add_u32 m0, s52, 34816
    s_mov_b32 exec_lo, s23
    s_nop 0
    buffer_load_dwordx4 v12, s[56:59], s54 offen lds
    s_mov_b32 exec_lo, -1
L_5:
    s_waitcnt vmcnt(11)
    s_barrier
    s_add_u32 s54, s49, 5
    s_and_b32 s54, s54, 7
    s_mul_i32 s55, s54, 196608
    s_lshl_b32 s54, s54, 7
    s_add_u32 m0, s53, 71680
    s_nop 0
    buffer_load_dwordx4 v10, s[56:59], s54 offen  lds
    buffer_load_dwordx4 v11, s[56:59], s54 offen offset:1024  lds
    s_add_u32 m0, s50, 79872
    s_nop 0
    buffer_load_dwordx4 v16, s[60:63], s55 offen  lds
    buffer_load_dwordx4 v16, s[60:63], s55 offen offset:1024  lds
    buffer_load_dwordx4 v16, s[60:63], s55 offen offset:2048  lds
    s_add_u32 m0, s50, 82944
    s_nop 0
    buffer_load_dwordx4 v17, s[60:63], s55 offen  lds
    buffer_load_dwordx4 v17, s[60:63], s55 offen offset:1024  lds
    buffer_load_dwordx4 v17, s[60:63], s55 offen offset:2048  lds
    s_cmp_ge_u32 s3, 2
    s_cbranch_scc1 L_6
    s_add_u32 m0, s52, 69632
    s_mov_b32 exec_lo, s23
    s_nop 0
    buffer_load_dwordx4 v12, s[56:59], s54 offen lds
    s_mov_b32 exec_lo, -1
L_6:
    s_waitcnt vmcnt(8)
    s_barrier
    s_add_u32 s54, s49, 6
    s_and_b32 s54, s54, 7
    s_mul_i32 s55, s54, 196608
    s_lshl_b32 s54, s54, 7
    s_add_u32 m0, s53, 2048
    s_nop 0
    buffer_load_dwordx4 v10, s[56:59], s54 offen  lds
    buffer_load_dwordx4 v11, s[56:59], s54 offen offset:1024  lds
    s_add_u32 m0, s50, 10240
    s_nop 0
    buffer_load_dwordx4 v16, s[60:63], s55 offen  lds
    buffer_load_dwordx4 v16, s[60:63], s55 offen offset:1024  lds
    buffer_load_dwordx4 v16, s[60:63], s55 offen offset:2048  lds
    s_add_u32 m0, s50, 13312
    s_nop 0
    buffer_load_dwordx4 v17, s[60:63], s55 offen  lds
    buffer_load_dwordx4 v17, s[60:63], s55 offen offset:1024  lds
    buffer_load_dwordx4 v17, s[60:63], s55 offen offset:2048  lds
    s_cmp_ge_u32 s3, 2
    s_cbranch_scc1 L_7
    s_add_u32 m0, s52, 0
    s_mov_b32 exec_lo, s23
    s_nop 0
    buffer_load_dwordx4 v12, s[56:59], s54 offen lds
    s_mov_b32 exec_lo, -1
L_7:
    s_waitcnt vmcnt(8)
    s_barrier
    s_add_u32 s54, s49, 7
    s_and_b32 s54, s54, 7
    s_mul_i32 s55, s54, 196608
    s_lshl_b32 s54, s54, 7
    s_add_u32 m0, s53, 36864
    s_nop 0
    buffer_load_dwordx4 v10, s[56:59], s54 offen  lds
    buffer_load_dwordx4 v11, s[56:59], s54 offen offset:1024  lds
    s_add_u32 m0, s50, 45056
    s_nop 0
    buffer_load_dwordx4 v16, s[60:63], s55 offen  lds
    buffer_load_dwordx4 v16, s[60:63], s55 offen offset:1024  lds
    buffer_load_dwordx4 v16, s[60:63], s55 offen offset:2048  lds
    s_add_u32 m0, s50, 48128
    s_nop 0
    buffer_load_dwordx4 v17, s[60:63], s55 offen  lds
    buffer_load_dwordx4 v17, s[60:63], s55 offen offset:1024  lds
    buffer_load_dwordx4 v17, s[60:63], s55 offen offset:2048  lds
    s_cmp_ge_u32 s3, 2
    s_cbranch_scc1 L_8
    s_add_u32 m0, s52, 34816
    s_mov_b32 exec_lo, s23
    s_nop 0
    buffer_load_dwordx4 v12, s[56:59], s54 offen lds
    s_mov_b32 exec_lo, -1
L_8:
    s_cmp_lg_u32 s3, 2
    s_cbranch_scc1 L_9
    s_mov_b64 exec, 1
    buffer_load_dword v6, v4, s[88:91], 0 offen offset:0 sc1
    s_mov_b64 exec, -1
L_9:
    ds_read_b64_tr_b16 v[24:25], v69 offset:0
    ds_read_b64_tr_b16 v[26:27], v69 offset:3072
    ds_read_b64_tr_b16 v[28:29], v70 offset:0
    ds_read_b64_tr_b16 v[30:31], v70 offset:3072
    ds_read_b64_tr_b16 v[32:33], v71 offset:0
    ds_read_b64_tr_b16 v[34:35], v71 offset:3072
    s_mul_i32 s4, s41, 11264
    s_add_u32 s4, s4, s84
    s_add_u32 s4, s4, s52
    s_add_u32 s5, s4, 4096
    s_add_u32 s6, s4, 8192
    s_cmp_eq_u32 s3, 3
    s_cselect_b32 s6, 0x1000000, s6
    s_lshl_b32 s7, s42, 4
    s_add_u32 s7, s7, s41
    s_mul_i32 s7, s7, 768
    s_add_u32 s7, s7, 0xc0000
    s_lshl_b32 s55, s3, 6
    s_add_u32 s7, s7, s55
    v_lshlrev_b32 v13, 2, v1
    v_lshl_add_u32 v13, v2, 8, v13
    s_waitcnt lgkmcnt(0)
    v_mfma_f32_16x16x32_bf16 v[40:43], v[36:39], v[24:27], 0
    buffer_store_dwordx4 v[24:27], v20, s[80:83], s4 offen sc1
    v_mfma_f32_16x16x32_bf16 v[44:47], v[36:39], v[28:31], 0
    buffer_store_dwordx4 v[28:31], v20, s[80:83], s5 offen sc1
    v_mfma_f32_16x16x32_bf16 v[48:51], v[36:39], v[32:35], 0
    buffer_store_dwordx4 v[32:35], v20, s[80:83], s6 offen sc1
    v_cmp_eq_u32 vcc, 1, v2
    s_nop 3
    v_cndmask_b32 v40, v40, v44, vcc
    v_cmp_eq_u32 vcc, 2, v2
    s_nop 1
    v_cndmask_b32 v40, v40, v48, vcc
    s_mov_b32 exec_hi, 0xffff
    buffer_store_dword v40, v13, s[44:47], s7 offen sc1
    s_mov_b64 exec, -1
    s_waitcnt vmcnt(12)
    s_barrier
    s_waitcnt vmcnt(0)
    s_cmp_lg_u32 s3, 2
    s_cbranch_scc1 L_10
    s_waitcnt vmcnt(4)
    s_mov_b32 s5, 0
L_12:
    v_cmp_gt_u32 vcc, 16, v6
    s_nop 0
    s_and_b64 vcc, vcc, 1
    s_cbranch_scc0 L_11
    s_add_u32 s5, s5, 1
    s_cmp_gt_u32 s5, 50000
    s_cbranch_scc1 L_11
    s_mov_b64 exec, 1
    buffer_load_dword v6, v4, s[88:91], 0 offen offset:0 sc1
    s_mov_b64 exec, -1
    s_waitcnt vmcnt(0)
    s_branch L_12
L_11:
L_10:
    s_barrier
    s_cmp_lg_u32 s3, 2
    s_cbranch_scc1 L_13
    v_lshlrev_b32 v13, 13, v0
    s_mov_b64 exec, 0xffff
    buffer_atomic_add v5, v13, s[44:47], s77 offen sc1
    s_mov_b64 exec, -1
L_13:
    s_add_u32 s55, s65, 0
    s_and_b32 s55, s55, 3
    s_add_u32 s55, s55, 4
    s_lshl_b32 s4, s55, 13
    s_add_u32 s4, s4, s53
    s_lshl_b32 s55, s55, 16
    s_add_u32 m0, s4, 92160
    s_nop 0
    buffer_load_dwordx4 v59, s[68:71], s55 offen  lds
    buffer_load_dwordx4 v60, s[68:71], s55 offen offset:1024  lds
    s_add_u32 s55, s65, 1
    s_and_b32 s55, s55, 3
    s_add_u32 s55, s55, 4
    s_lshl_b32 s4, s55, 13
    s_add_u32 s4, s4, s53
    s_lshl_b32 s55, s55, 16
    s_add_u32 m0, s4, 92160
    s_nop 0
    buffer_load_dwordx4 v59, s[68:71], s55 offen  lds
    buffer_load_dwordx4 v60, s[68:71], s55 offen offset:1024  lds
    s_add_u32 s55, s65, 2
    s_and_b32 s55, s55, 3
    s_add_u32 s55, s55, 4
    s_lshl_b32 s4, s55, 13
    s_add_u32 s4, s4, s53
    s_lshl_b32 s55, s55, 16
    s_add_u32 m0, s4, 92160
    s_nop 0
    buffer_load_dwordx4 v59, s[68:71], s55 offen  lds
    buffer_load_dwordx4 v60, s[68:71], s55 offen offset:1024  lds
    s_mov_b32 s72, s28
    s_mov_b32 s73, s29
    s_mov_b32 s74, 1409024
    s_lshl_b32 s4, s2, 2
    s_add_u32 s4, s4, s3
    s_mul_i32 s4, s4, 1376
    v_mul_u32_u24 v13, 22, v0
    v_and_b32 v13, 0xffc, v13
    buffer_load_dwordx4 a[76:79], v13, s[72:75], s4 offen
    s_barrier
    s_setprio 0
    s_lshl_b32 s7, s41, 13
    s_add_u32 s7, s7, s77
    s_mov_b64 exec, 1
    v_mov_b32 v6, 0
    buffer_atomic_add v6, v4, s[44:47], s7 offen offset:0 sc0 sc1
    s_mov_b64 exec, -1
    s_add_u32 s55, s65, 3
    s_and_b32 s55, s55, 3
    s_add_u32 s55, s55, 4
    s_lshl_b32 s4, s55, 13
    s_add_u32 s4, s4, s53
    s_lshl_b32 s55, s55, 16
    s_add_u32 m0, s4, 92160
    s_nop 0
    buffer_load_dwordx4 v59, s[68:71], s55 offen  lds
    buffer_load_dwordx4 v60, s[68:71], s55 offen offset:1024  lds
    s_add_u32 s55, s65, 4
    s_and_b32 s55, s55, 3
    s_lshl_b32 s4, s55, 13
    s_add_u32 s4, s4, s53
    s_lshl_b32 s55, s55, 16
    s_add_u32 m0, s4, 92160
    s_nop 0
    buffer_load_dwordx4 v59, s[68:71], s55 offen  lds
    buffer_load_dwordx4 v60, s[68:71], s55 offen offset:1024  lds
    s_add_u32 s55, s65, 5
    s_and_b32 s55, s55, 3
    s_lshl_b32 s4, s55, 13
    s_add_u32 s4, s4, s53
    s_lshl_b32 s55, s55, 16
    s_add_u32 m0, s4, 92160
    s_nop 0
    buffer_load_dwordx4 v59, s[68:71], s55 offen  lds
    buffer_load_dwordx4 v60, s[68:71], s55 offen offset:1024  lds
    s_add_u32 s55, s65, 6
    s_and_b32 s55, s55, 3
    s_lshl_b32 s4, s55, 13
    s_add_u32 s4, s4, s53
    s_lshl_b32 s55, s55, 16
    s_add_u32 m0, s4, 92160
    s_nop 0
    buffer_load_dwordx4 v59, s[68:71], s55 offen  lds
    buffer_load_dwordx4 v60, s[68:71], s55 offen offset:1024  lds
    s_add_u32 s55, s65, 7
    s_and_b32 s55, s55, 3
    s_lshl_b32 s4, s55, 13
    s_add_u32 s4, s4, s53
    s_lshl_b32 s55, s55, 16
    s_add_u32 m0, s4, 92160
    s_nop 0
    buffer_load_dwordx4 v59, s[68:71], s55 offen  lds
    buffer_load_dwordx4 v60, s[68:71], s55 offen offset:1024  lds
    s_add_u32 m0, s53, 73728
    s_nop 0
    buffer_load_dwordx4 v93, s[56:59], 0 offen  lds
    buffer_load_dwordx4 v94, s[56:59], 0 offen offset:1024  lds
    s_waitcnt vmcnt(12)
    s_mov_b32 s5, 0
L_15:
    v_cmp_gt_u32 vcc, 16, v6
    s_nop 0
    s_and_b64 vcc, vcc, 1
    s_cbranch_scc0 L_14
    s_add_u32 s5, s5, 1
    s_cmp_gt_u32 s5, 50000
    s_cbranch_scc1 L_14
    s_mov_b64 exec, 1
    v_mov_b32 v6, 0
    buffer_atomic_add v6, v4, s[44:47], s7 offen offset:0 sc0 sc1
    s_mov_b64 exec, -1
    s_waitcnt vmcnt(0)
    s_branch L_15
L_14:
    s_add_u32 s55, s41, 0
    s_and_b32 s55, s55, 7
    s_mul_i32 s55, s55, 22528
    s_add_u32 s55, s55, s84
    s_add_u32 s4, s55, s85
    s_add_u32 m0, s85, 0
    s_nop 0
    buffer_load_dwordx4 v20, s[80:83], s4 offen sc1 lds
    buffer_load_dwordx4 v20, s[80:83], s4 offen offset:1024 sc1 lds
    buffer_load_dwordx4 v20, s[80:83], s4 offen offset:2048 sc1 lds
    buffer_load_dwordx4 v20, s[80:83], s4 offen offset:3072 sc1 lds
    s_add_u32 s4, s4, 4096
    s_add_u32 m0, s85, 4096
    s_nop 0
    buffer_load_dwordx4 v20, s[80:83], s4 offen sc1 lds
    s_cmp_ge_u32 s3, 2
    s_cbranch_scc1 L_16
    s_add_u32 s4, s55, s86
    s_add_u32 m0, s86, 0
    s_nop 0
    buffer_load_dwordx4 v20, s[80:83], s4 offen sc1 lds
L_16:
    s_add_u32 s55, s41, 1
    s_and_b32 s55, s55, 7
    s_mul_i32 s55, s55, 22528
    s_add_u32 s55, s55, s84
    s_add_u32 s4, s55, s85
    s_add_u32 m0, s85, 22528
    s_nop 0
    buffer_load_dwordx4 v20, s[80:83], s4 offen sc1 lds
    buffer_load_dwordx4 v20, s[80:83], s4 offen offset:1024 sc1 lds
    buffer_load_dwordx4 v20, s[80:83], s4 offen offset:2048 sc1 lds
    buffer_load_dwordx4 v20, s[80:83], s4 offen offset:3072 sc1 lds
    s_add_u32 s4, s4, 4096
    s_add_u32 m0, s85, 26624
    s_nop 0
    buffer_load_dwordx4 v20, s[80:83], s4 offen sc1 lds
    s_cmp_ge_u32 s3, 2
    s_cbranch_scc1 L_17
    s_add_u32 s4, s55, s86
    s_add_u32 m0, s86, 22528
    s_nop 0
    buffer_load_dwordx4 v20, s[80:83], s4 offen sc1 lds
L_17:
    s_add_u32 s55, s41, 2
    s_and_b32 s55, s55, 7
    s_mul_i32 s55, s55, 22528
    s_add_u32 s55, s55, s84
    s_add_u32 s4, s55, s85
    s_add_u32 m0, s85, 45056
    s_nop 0
    buffer_load_dwordx4 v20, s[80:83], s4 offen sc1 lds
    buffer_load_dwordx4 v20, s[80:83], s4 offen offset:1024 sc1 lds
    buffer_load_dwordx4 v20, s[80:83], s4 offen offset:2048 sc1 lds
    buffer_load_dwordx4 v20, s[80:83], s4 offen offset:3072 sc1 lds
    s_add_u32 s4, s4, 4096
    s_add_u32 m0, s85, 49152
    s_nop 0
    buffer_load_dwordx4 v20, s[80:83], s4 offen sc1 lds
    s_cmp_ge_u32 s3, 2
    s_cbranch_scc1 L_18
    s_add_u32 s4, s55, s86
    s_add_u32 m0, s86, 45056
    s_nop 0
    buffer_load_dwordx4 v20, s[80:83], s4 offen sc1 lds
L_18:
    s_mov_b32 s56, s28
    s_mov_b32 s57, s29
    s_mov_b32 s58, 0x158000
    s_mov_b32 s59, 0x20000
    s_add_u32 s60, s34, 0x200000
    s_addc_u32 s61, s35, 0
    s_mov_b32 s62, 0x200000
    s_mov_b32 s63, 0x20000
    s_lshl_b32 s4, s3, 8
    v_lshl_add_u32 v96, v0, 2, s4
    s_mul_i32 s6, s42, 12288
    s_add_u32 s6, s6, 0xc0000
    v_add_u32 v99, s85, v20
    v_add_u32 v100, s86, v20
    v_add_u32 v101, s53, v20
    s_add_u32 s55, s41, 3
    s_and_b32 s55, s55, 7
    s_mul_i32 s55, s55, 22528
    s_add_u32 s55, s55, s84
    s_waitcnt vmcnt(5)
    s_add_u32 s4, s55, s85
    buffer_load_dwordx4 a[0:3], v20, s[80:83], s4 offen offset:0 sc1
    buffer_load_dwordx4 a[4:7], v20, s[80:83], s4 offen offset:1024 sc1
    buffer_load_dwordx4 a[8:11], v20, s[80:83], s4 offen offset:2048 sc1
    buffer_load_dwordx4 a[12:15], v20, s[80:83], s4 offen offset:3072 sc1
    s_add_u32 s4, s4, 4096
    buffer_load_dwordx4 a[16:19], v20, s[80:83], s4 offen sc1
    s_cmp_ge_u32 s3, 2
    s_cbranch_scc1 L_19
    s_add_u32 s4, s55, s86
    buffer_load_dwordx4 a[20:23], v20, s[80:83], s4 offen sc1
L_19:
    s_add_u32 s5, s6, 0
    buffer_load_dword v40, v96, s[44:47], s5 offen offset:0 sc1
    buffer_load_dword v41, v96, s[44:47], s5 offen offset:768 sc1
    buffer_load_dword v42, v96, s[44:47], s5 offen offset:1536 sc1
    buffer_load_dword v43, v96, s[44:47], s5 offen offset:2304 sc1
    s_add_u32 s5, s6, 3072
    buffer_load_dword v44, v96, s[44:47], s5 offen offset:0 sc1
    buffer_load_dword v45, v96, s[44:47], s5 offen offset:768 sc1
    buffer_load_dword v46, v96, s[44:47], s5 offen offset:1536 sc1
    buffer_load_dword v47, v96, s[44:47], s5 offen offset:2304 sc1
    s_add_u32 s5, s6, 6144
    buffer_load_dword v48, v96, s[44:47], s5 offen offset:0 sc1
    buffer_load_dword v49, v96, s[44:47], s5 offen offset:768 sc1
    buffer_load_dword v50, v96, s[44:47], s5 offen offset:1536 sc1
    buffer_load_dword v51, v96, s[44:47], s5 offen offset:2304 sc1
    s_add_u32 s5, s6, 9216
    buffer_load_dword v52, v96, s[44:47], s5 offen offset:0 sc1
    buffer_load_dword v53, v96, s[44:47], s5 offen offset:768 sc1
    buffer_load_dword v54, v96, s[44:47], s5 offen offset:1536 sc1
    buffer_load_dword v55, v96, s[44:47], s5 offen offset:2304 sc1
    s_waitcnt vmcnt(36)
    s_barrier
    s_barrier
    s_waitcnt vmcnt(0)
    v_add_f32 v40, v40, v48
    v_add_f32 v41, v41, v49
    v_add_f32 v42, v42, v50
    v_add_f32 v43, v43, v51
    v_add_f32 v44, v44, v52
    v_add_f32 v45, v45, v53
    v_add_f32 v46, v46, v54
    v_add_f32 v47, v47, v55
    v_add_f32 v40, v40, v44
    v_add_f32 v41, v41, v45
    v_add_f32 v42, v42, v46
    v_add_f32 v43, v43, v47
    v_add_f32 v40, v40, v42
    v_add_f32 v41, v41, v43
    v_add_f32 v40, v40, v41
    v_add_u32 v96, 159744, v96
    ds_write_b32 v96, v40
    s_cmp_lg_u32 s3, 1
    s_cbranch_scc1 L_20
    s_lshl_b32 s4, s14, 10
    buffer_load_dwordx4 v[48:51], v20, s[8:11], s4 offen sc1
L_20:
    s_add_u32 s55, s41, 4
    s_and_b32 s55, s55, 7
    s_mul_i32 s55, s55, 22528
    s_add_u32 s55, s55, s84
    s_add_u32 s4, s55, s85
    buffer_load_dwordx4 a[24:27], v20, s[80:83], s4 offen offset:0 sc1
    buffer_load_dwordx4 a[28:31], v20, s[80:83], s4 offen offset:1024 sc1
    buffer_load_dwordx4 a[32:35], v20, s[80:83], s4 offen offset:2048 sc1
    buffer_load_dwordx4 a[36:39], v20, s[80:83], s4 offen offset:3072 sc1
    s_add_u32 s4, s4, 4096
    buffer_load_dwordx4 a[40:43], v20, s[80:83], s4 offen sc1
    s_cmp_ge_u32 s3, 2
    s_cbranch_scc1 L_21
    s_add_u32 s4, s55, s86
    buffer_load_dwordx4 a[44:47], v20, s[80:83], s4 offen sc1
L_21:
    s_add_u32 s55, s41, 5
    s_and_b32 s55, s55, 7
    s_mul_i32 s55, s55, 22528
    s_add_u32 s55, s55, s84
    s_add_u32 s4, s55, s85
    buffer_load_dwordx4 a[48:51], v20, s[80:83], s4 offen offset:0 sc1
    buffer_load_dwordx4 a[52:55], v20, s[80:83], s4 offen offset:1024 sc1
    buffer_load_dwordx4 a[56:59], v20, s[80:83], s4 offen offset:2048 sc1
    buffer_load_dwordx4 a[60:63], v20, s[80:83], s4 offen offset:3072 sc1
    s_add_u32 s4, s4, 4096
    buffer_load_dwordx4 a[64:67], v20, s[80:83], s4 offen sc1
    s_cmp_ge_u32 s3, 2
    s_cbranch_scc1 L_22
    s_add_u32 s4, s55, s86
    buffer_load_dwordx4 a[68:71], v20, s[80:83], s4 offen sc1
L_22:
    v_and_b32 v13, 1, v2
    v_lshlrev_b32 v97, 11, v13
    v_lshl_add_u32 v97, v1, 3, v97
    v_lshrrev_b32 v14, 1, v2
    v_lshl_add_u32 v97, v14, 10, v97
    s_lshl_b32 s76, s41, 14
    s_lshl_b32 s4, s3, 12
    s_add_u32 s76, s76, s4
    s_add_u32 s76, s76, 0x20000
    v_and_b32 v98, 31, v0
    s_lshl_b32 s4, s3, 9
    s_add_u32 s4, s4, 157696
    v_lshl_add_u32 v98, v98, 4, s4
    s_waitcnt vmcnt(31)
    s_barrier
    s_barrier
    v_add_u32 v99, 67584, v99
    v_add_u32 v100, 67584, v100
    s_waitcnt vmcnt(26)
    ds_write_b128 v99, a[0:3] offset:0
    ds_write_b128 v99, a[4:7] offset:1024
    ds_write_b128 v99, a[8:11] offset:2048
    ds_write_b128 v99, a[12:15] offset:3072
    ds_write_b128 v99, a[16:19] offset:4096
    s_cmp_ge_u32 s3, 2
    s_cbranch_scc1 L_23
    ds_write_b128 v100, a[20:23] offset:0
L_23:
    s_waitcnt vmcnt(5)
    ds_write_b128 v99, a[24:27] offset:22528
    ds_write_b128 v99, a[28:31] offset:23552
    ds_write_b128 v99, a[32:35] offset:24576
    ds_write_b128 v99, a[36:39] offset:25600
    ds_write_b128 v99, a[40:43] offset:26624
    s_cmp_ge_u32 s3, 2
    s_cbranch_scc1 L_24
    ds_write_b128 v100, a[44:47] offset:22528
L_24:
    v_add_u32 v99, 45056, v99
    v_add_u32 v100, 45056, v100
    s_waitcnt vmcnt(0)
    ds_write_b128 v99, a[48:51] offset:0
    ds_write_b128 v99, a[52:55] offset:1024
    ds_write_b128 v99, a[56:59] offset:2048
    ds_write_b128 v99, a[60:63] offset:3072
    ds_write_b128 v99, a[64:67] offset:4096
    s_cmp_ge_u32 s3, 2
    s_cbranch_scc1 L_25
    ds_write_b128 v100, a[68:71] offset:0
L_25:
    s_waitcnt lgkmcnt(0)
    s_barrier
    s_lshr_b32 s49, s38, 6
    s_barrier
    buffer_load_dwordx2 v[24:25], v97, s[44:47], s76 offen offset:0 sc1
    buffer_load_dwordx2 v[26:27], v97, s[44:47], s76 offen offset:128 sc1
    buffer_load_dwordx2 v[28:29], v97, s[44:47], s76 offen offset:256 sc1
    buffer_load_dwordx2 v[30:31], v97, s[44:47], s76 offen offset:384 sc1
    buffer_load_dwordx2 v[32:33], v97, s[44:47], s76 offen offset:512 sc1
    buffer_load_dwordx2 v[34:35], v97, s[44:47], s76 offen offset:640 sc1
    buffer_load_dwordx2 v[36:37], v97, s[44:47], s76 offen offset:768 sc1
    buffer_load_dwordx2 v[38:39], v97, s[44:47], s76 offen offset:896 sc1
    s_waitcnt vmcnt(0)
    v_add_f32 v24, v24, v26
    v_add_f32 v25, v25, v27
    v_add_f32 v28, v28, v30
    v_add_f32 v29, v29, v31
    v_add_f32 v32, v32, v34
    v_add_f32 v33, v33, v35
    v_add_f32 v36, v36, v38
    v_add_f32 v37, v37, v39
    v_add_f32 v24, v24, v28
    v_add_f32 v32, v32, v36
    v_add_f32 v25, v25, v29
    v_add_f32 v33, v33, v37
    v_add_f32 v24, v24, v32
    v_add_f32 v25, v25, v33
    v_mov_b32 v28, v24
    v_mov_b32 v29, v25
    s_nop 0
    v_permlane32_swap_b32 v24, v28
    v_permlane32_swap_b32 v25, v29
    v_add_f32 v24, v24, v28
    v_add_f32 v25, v25, v29
    v_mul_f32 v33, 0xbb000000, v24
    v_mul_f32 v32, 0x3b000000, v25
    v_fma_f32 v32, -v33, v33, v32
    v_max_f32 v32, 0, v32
    v_add_f32 v32, 0x3727c5ac, v32
    v_rsq_f32 v28, v32
    s_nop 0
    v_mul_f32 v34, 0xc0135761, v28
    v_mul_f32 v35, v28, v28
    v_mul_f32 v35, v35, v28
    v_mul_f32 v35, 0xbdd2d3e8, v35
    ds_write_b128 v98, v[32:35]
    v_lshrrev_b32 v13, 3, v0
    v_lshlrev_b32 v13, 10, v13
    v_and_b32 v14, 7, v0
    v_lshl_add_u32 v13, v14, 4, v13
    s_lshl_b32 s4, s14, 2
    s_add_u32 s4, s4, s3
    s_mul_i32 s4, s4, 11264
    buffer_load_dwordx4 v[48:51], v13, s[56:59], s4 offen offset:384
    s_add_u32 s4, s4, 3072
    buffer_load_dwordx4 v[52:55], v13, s[56:59], s4 offen offset:384
    s_waitcnt vmcnt(2)
    s_barrier
    s_add_u32 s55, s41, 6
    s_and_b32 s55, s55, 7
    s_mul_i32 s55, s55, 22528
    s_add_u32 s55, s55, s84
    s_add_u32 s4, s55, s85
    s_add_u32 m0, s85, 135168
    s_nop 0
    buffer_load_dwordx4 v20, s[80:83], s4 offen sc1 lds
    buffer_load_dwordx4 v20, s[80:83], s4 offen offset:1024 sc1 lds
    buffer_load_dwordx4 v20, s[80:83], s4 offen offset:2048 sc1 lds
    buffer_load_dwordx4 v20, s[80:83], s4 offen offset:3072 sc1 lds
    s_add_u32 s4, s4, 4096
    s_add_u32 m0, s85, 139264
    s_nop 0
    buffer_load_dwordx4 v20, s[80:83], s4 offen sc1 lds
    s_cmp_ge_u32 s3, 2
    s_cbranch_scc1 L_26
    s_add_u32 s4, s55, s86
    s_add_u32 m0, s86, 135168
    s_nop 0
    buffer_load_dwordx4 v20, s[80:83], s4 offen sc1 lds
L_26:
    s_add_u32 s55, s41, 7
    s_and_b32 s55, s55, 7
    s_mul_i32 s55, s55, 22528
    s_add_u32 s55, s55, s84
    s_add_u32 s4, s55, s85
    s_add_u32 m0, s85, 0
    s_nop 0
    buffer_load_dwordx4 v20, s[80:83], s4 offen sc1 lds
    buffer_load_dwordx4 v20, s[80:83], s4 offen offset:1024 sc1 lds
    buffer_load_dwordx4 v20, s[80:83], s4 offen offset:2048 sc1 lds
    buffer_load_dwordx4 v20, s[80:83], s4 offen offset:3072 sc1 lds
    s_add_u32 s4, s4, 4096
    s_add_u32 m0, s85, 4096
    s_nop 0
    buffer_load_dwordx4 v20, s[80:83], s4 offen sc1 lds
    s_cmp_ge_u32 s3, 2
    s_cbranch_scc1 L_27
    s_add_u32 s4, s55, s86
    s_add_u32 m0, s86, 0
    s_nop 0
    buffer_load_dwordx4 v20, s[80:83], s4 offen sc1 lds
L_27:
    s_waitcnt vmcnt(8)
    s_add_u32 s55, s49, 3
    s_and_b32 s55, s55, 3
    s_mul_i32 s55, s55, 180224
    s_add_u32 m0, s53, 24576
    s_nop 0
    buffer_load_dwordx4 v61, s[56:59], s55 offen  lds
    buffer_load_dwordx4 v62, s[56:59], s55 offen offset:1024  lds
    s_waitcnt vmcnt(8)
    s_add_u32 s55, s49, 4
    s_and_b32 s55, s55, 3
    s_mul_i32 s55, s55, 180224
    s_add_u32 s55, s55, 49152
    s_add_u32 m0, s53, 32768
    s_nop 0
    buffer_load_dwordx4 v61, s[56:59], s55 offen  lds
    buffer_load_dwordx4 v62, s[56:59], s55 offen offset:1024  lds
    s_waitcnt vmcnt(8)
    s_add_u32 s55, s49, 5
    s_and_b32 s55, s55, 3
    s_mul_i32 s55, s55, 180224
    s_add_u32 s55, s55, 49152
    s_add_u32 m0, s53, 40960
    s_nop 0
    buffer_load_dwordx4 v61, s[56:59], s55 offen  lds
    buffer_load_dwordx4 v62, s[56:59], s55 offen offset:1024  lds
    s_waitcnt vmcnt(8)
    s_add_u32 s55, s49, 6
    s_and_b32 s55, s55, 3
    s_mul_i32 s55, s55, 180224
    s_add_u32 s55, s55, 49152
    s_add_u32 m0, s53, 49152
    s_nop 0
    buffer_load_dwordx4 v61, s[56:59], s55 offen  lds
    buffer_load_dwordx4 v62, s[56:59], s55 offen offset:1024  lds
    s_waitcnt vmcnt(8)
    s_barrier
    s_waitcnt vmcnt(8)
    s_add_u32 s55, s49, 7
    s_and_b32 s55, s55, 3
    s_mul_i32 s55, s55, 180224
    s_add_u32 s55, s55, 49152
    s_add_u32 m0, s53, 57344
    s_nop 0
    buffer_load_dwordx4 v61, s[56:59], s55 offen  lds
    buffer_load_dwordx4 v62, s[56:59], s55 offen offset:1024  lds
    s_waitcnt vmcnt(8)
    s_mov_b32 s55, 0
    s_add_u32 m0, s53, 65536
    s_nop 0
    buffer_load_dwordx4 v63, s[56:59], s55 offen  lds
    buffer_load_dwordx4 v64, s[56:59], s55 offen offset:1024  lds
    s_waitcnt vmcnt(8)
    s_add_u32 s55, s49, 0
    s_and_b32 s55, s55, 3
    s_mul_i32 s55, s55, 180224
    s_add_u32 s55, s55, 720896
    s_add_u32 m0, s53, 73728
    s_nop 0
    buffer_load_dwordx4 v61, s[56:59], s55 offen  lds
    buffer_load_dwordx4 v62, s[56:59], s55 offen offset:1024  lds
    s_waitcnt vmcnt(8)
    s_add_u32 s55, s49, 1
    s_and_b32 s55, s55, 3
    s_mul_i32 s55, s55, 180224
    s_add_u32 s55, s55, 720896
    s_add_u32 m0, s53, 81920
    s_nop 0
    buffer_load_dwordx4 v61, s[56:59], s55 offen  lds
    buffer_load_dwordx4 v62, s[56:59], s55 offen offset:1024  lds
    s_waitcnt vmcnt(8)
    s_add_u32 s55, s49, 2
    s_and_b32 s55, s55, 3
    s_mul_i32 s55, s55, 180224
    s_add_u32 s55, s55, 720896
    s_add_u32 m0, s53, 90112
    s_nop 0
    buffer_load_dwordx4 v61, s[56:59], s55 offen  lds
    buffer_load_dwordx4 v62, s[56:59], s55 offen offset:1024  lds
    s_waitcnt vmcnt(8)
    s_add_u32 s55, s49, 3
    s_and_b32 s55, s55, 3
    s_mul_i32 s55, s55, 180224
    s_add_u32 s55, s55, 720896
    s_add_u32 m0, s53, 98304
    s_nop 0
    buffer_load_dwordx4 v61, s[56:59], s55 offen  lds
    buffer_load_dwordx4 v62, s[56:59], s55 offen offset:1024  lds
    s_waitcnt vmcnt(8)
    s_mov_b32 s55, 360448
    buffer_load_dwordx4 a[0:3], v63, s[56:59], s55 offen
    buffer_load_dwordx4 a[4:7], v64, s[56:59], s55 offen offset:1024
    s_waitcnt vmcnt(8)
    s_mov_b32 s55, 0
    buffer_load_dwordx4 a[8:11], v65, s[56:59], s55 offen
    buffer_load_dwordx4 a[12:15], v66, s[56:59], s55 offen offset:1024
    s_waitcnt lgkmcnt(0)
    s_barrier
    s_setprio 0
    s_waitcnt vmcnt(8)
    s_add_u32 s55, s49, 4
    s_and_b32 s55, s55, 3
    s_mul_i32 s55, s55, 180224
    s_add_u32 s55, s55, 770048
    s_add_u32 m0, s53, 106496
    s_nop 0
    buffer_load_dwordx4 v61, s[56:59], s55 offen  lds
    buffer_load_dwordx4 v62, s[56:59], s55 offen offset:1024  lds
    s_waitcnt vmcnt(8)
    s_add_u32 s55, s49, 5
    s_and_b32 s55, s55, 3
    s_mul_i32 s55, s55, 180224
    s_add_u32 s55, s55, 770048
    s_add_u32 m0, s53, 114688
    s_nop 0
    buffer_load_dwordx4 v61, s[56:59], s55 offen  lds
    buffer_load_dwordx4 v62, s[56:59], s55 offen offset:1024  lds
    s_waitcnt vmcnt(8)
    s_add_u32 s55, s49, 6
    s_and_b32 s55, s55, 3
    s_mul_i32 s55, s55, 180224
    s_add_u32 s55, s55, 770048
    s_add_u32 m0, s53, 122880
    s_nop 0
    buffer_load_dwordx4 v61, s[56:59], s55 offen  lds
    buffer_load_dwordx4 v62, s[56:59], s55 offen offset:1024  lds
    s_waitcnt vmcnt(8)
    s_add_u32 s55, s49, 7
    s_and_b32 s55, s55, 3
    s_mul_i32 s55, s55, 180224
    s_add_u32 s55, s55, 770048
    s_add_u32 m0, s53, 131072
    s_nop 0
    buffer_load_dwordx4 v61, s[56:59], s55 offen  lds
    buffer_load_dwordx4 v62, s[56:59], s55 offen offset:1024  lds
    s_waitcnt vmcnt(8)
    s_mov_b32 s55, 720896
    s_add_u32 m0, s53, 139264
    s_nop 0
    buffer_load_dwordx4 v63, s[56:59], s55 offen  lds
    buffer_load_dwordx4 v64, s[56:59], s55 offen offset:1024  lds
    s_waitcnt vmcnt(8)
    s_add_u32 s55, s49, 0
    s_and_b32 s55, s55, 3
    s_mul_i32 s55, s55, 180224
    s_add_u32 m0, s53, 0
    s_nop 0
    buffer_load_dwordx4 v61, s[56:59], s55 offen  lds
    buffer_load_dwordx4 v62, s[56:59], s55 offen offset:1024  lds
    s_waitcnt vmcnt(8)
    s_add_u32 s55, s49, 1
    s_and_b32 s55, s55, 3
    s_mul_i32 s55, s55, 180224
    s_add_u32 m0, s53, 8192
    s_nop 0
    buffer_load_dwordx4 v61, s[56:59], s55 offen  lds
    buffer_load_dwordx4 v62, s[56:59], s55 offen offset:1024  lds
    s_waitcnt vmcnt(8)
    s_add_u32 s55, s49, 2
    s_and_b32 s55, s55, 3
    s_mul_i32 s55, s55, 180224
    s_add_u32 m0, s53, 16384
    s_nop 0
    buffer_load_dwordx4 v61, s[56:59], s55 offen  lds
    buffer_load_dwordx4 v62, s[56:59], s55 offen offset:1024  lds
    s_waitcnt vmcnt(8)
    s_mov_b32 s55, 1081344
    buffer_load_dwordx4 a[16:19], v63, s[56:59], s55 offen
    buffer_load_dwordx4 a[20:23], v64, s[56:59], s55 offen offset:1024
    s_waitcnt vmcnt(8)
    s_mov_b32 s55, 720896
    buffer_load_dwordx4 a[24:27], v65, s[56:59], s55 offen
    buffer_load_dwordx4 a[28:31], v66, s[56:59], s55 offen offset:1024
    s_waitcnt vmcnt(4)
    s_barrier
    v_add_u32 v99, 73728, v101
    s_waitcnt vmcnt(0)
    s_barrier
    ds_write_b128 v101, a[0:3] offset:0
    ds_write_b128 v101, a[4:7] offset:1024
    ds_write_b128 v101, a[8:11] offset:8192
    ds_write_b128 v101, a[12:15] offset:9216
    ds_write_b128 v99, a[16:19] offset:0
    ds_write_b128 v99, a[20:23] offset:1024
    ds_write_b128 v99, a[24:27] offset:8192
    ds_write_b128 v99, a[28:31] offset:9216
    s_waitcnt lgkmcnt(0)
    s_barrier
    s_barrier
    s_endpgm
L_end:
    s_endpgm
L_code_end:
.section .rodata,"a"
.p2align 6
.amdhsa_kernel sequential_preLN__sliding_local_dilated__glu_gated_geglu__prompt_kernel
  .amdhsa_next_free_vgpr 256
  .amdhsa_next_free_sgpr 102
  .amdhsa_accum_offset 176
  .amdhsa_group_segment_fixed_size 0
  .amdhsa_kernarg_size 80
  .amdhsa_user_sgpr_count 2
  .amdhsa_user_sgpr_kernarg_segment_ptr 1
  .amdhsa_system_sgpr_workgroup_id_x 1
.end_amdhsa_kernel
```
